```python
import torch

def _softmax(x, axis=-1):
    return torch.softmax(x, dim=axis)
def _gelu(x):
    return torch.nn.functional.gelu(x, approximate="tanh")
def _silu(x):
    return torch.nn.functional.silu(x)
def _sigmoid(x):
    return torch.sigmoid(x)
def _layernorm(x, axis=-1, eps=1e-5):
    m = x.mean(dim=axis, keepdim=True)
    v = x.var(dim=axis, keepdim=True, unbiased=False)
    return (x - m) / torch.sqrt(v + eps)
def _scatter_add(tgt, idx, src, axis=0):
    return tgt.clone().index_add_(axis, idx, src)
def _segment_sum(src, seg, n):
    out = torch.zeros((n,) + src.shape[1:], dtype=src.dtype)
    return out.index_add_(0, seg, src)
def _pad(x, pw):
    flat = tuple(v for pair in reversed(pw) for v in pair)
    return torch.nn.functional.pad(x, flat)

kernel_name = 'parallel_sum__ssm_conv_h3__mixer_s_mlp__prompt'

def setup_inputs():

    _w = (lambda a: (lambda t: t.to(torch.bfloat16) if t.is_floating_point() else t)(torch.as_tensor(a)))
    def _A_setup():
        B, S, D = 1, 2048, 512
        ks = 4
        return {
            "q": _w((lambda *s: torch.randn(*s, dtype=torch.bfloat16) * 0.05)(B, S, D)),
            "k": _w((lambda *s: torch.randn(*s, dtype=torch.bfloat16) * 0.8)(B, S, D)),
            "v": _w((lambda *s: torch.randn(*s, dtype=torch.bfloat16) * 0.8)(B, S, D)),
            "shift_k": _w((lambda *s: torch.randn(*s, dtype=torch.bfloat16) * 0.8)(D, ks) * 0.5),
            "ssm_k": _w((lambda *s: torch.randn(*s, dtype=torch.bfloat16) * 1.6)(D, S) * (1.0 / S ** 0.5)),
            "ssm_D": _w((lambda *s: torch.randn(*s, dtype=torch.bfloat16) * 0.8)(D)),
        }
    _A_in = _A_setup()

    def _B_setup():
        B, S, D, F = 1, 2048, 512, 1792
        return {
            "x":  _w((lambda *s: torch.randn(*s, dtype=torch.bfloat16) * 0.05)(B, S, D)),
            "w1": _w((lambda *s: torch.randn(*s, dtype=torch.bfloat16) * 3.2)(D, D) * (D ** -0.5)),
            "w2": _w((lambda *s: torch.randn(*s, dtype=torch.bfloat16) * 3.2)(D, D) * (D ** -0.5)),
            "w3": _w((lambda *s: torch.randn(*s, dtype=torch.bfloat16) * 3.2)(D, F) * (D ** -0.5)),
            "w4": _w((lambda *s: torch.randn(*s, dtype=torch.bfloat16) * 1.6)(F, D) * (F ** -0.5)),
        }
    _B_in = _B_setup()

    return {
        "A_q": _A_in["q"],
        "A_k": _A_in["k"],
        "A_v": _A_in["v"],
        "A_shift_k": _A_in["shift_k"],
        "A_ssm_k": _A_in["ssm_k"],
        "A_ssm_D": _A_in["ssm_D"],
        "B_x": _B_in["x"],
        "B_w1": _B_in["w1"],
        "B_w2": _B_in["w2"],
        "B_w3": _B_in["w3"],
        "B_w4": _B_in["w4"],
    }

def reference(A_q, A_k, A_v, A_shift_k, A_ssm_k, A_ssm_D, B_x, B_w1, B_w2, B_w3, B_w4):
    def _A_ref(q, k, v, shift_k, ssm_k, ssm_D):
        B, S, D = q.shape
        ks = shift_k.shape[-1]
        k_pad = _pad(k, ((0, 0), (ks - 1, 0), (0, 0)))
        k_shift = torch.zeros_like(k)
        for t in range(ks):
            k_shift = k_shift + k_pad[:, t:t + S, :] * shift_k[:, ks - 1 - t][None, None, :]
        kv = k_shift * v
        L = 2 * S
        kv_pad = _pad(kv, ((0, 0), (0, S), (0, 0)))
        kf_pad = _pad(ssm_k, ((0, 0), (0, S)))
        kv_f = (lambda x, axes=(-2,-1): torch.fft.rfft2(x.float(), dim=axes))(kv_pad[:, None, :, :], axes=(1, 2))
        kf_f = (lambda x, axes=(-2,-1): torch.fft.rfft2(x.float(), dim=axes))(kf_pad[:, None, :], axes=(1, 2))
        kf_f = (lambda x, *d: x.permute(*d))(kf_f, 1, 2, 0)
        y_f = kv_f * kf_f[None, :, :, :]
        y = (lambda x, s, axes=(-2,-1): torch.fft.irfft2(x, s=s, dim=axes).to(torch.bfloat16))(y_f, (1, L), axes=(1, 2))[:, 0, :S, :]
        y = y + kv * ssm_D[None, None, :]
        return q * y

    def _B_ref(x, w1, w2, w3, w4):
        B, S, D = x.shape
        h = _gelu(_layernorm(x, axis=-1) @ w1)
        c = D // 4
        g0 = _pad(h[:, :, 0*c:1*c], ((0, 0), (1, 0), (0, 0)))[:, :S, :]
        g1 = _pad(h[:, :, 1*c:2*c], ((0, 0), (0, 1), (0, 0)))[:, 1:, :]
        g2 = _pad(h[:, :, 2*c:3*c], ((0, 0), (2, 0), (0, 0)))[:, :S, :]
        g3 = _pad(h[:, :, 3*c:   ], ((0, 0), (0, 2), (0, 0)))[:, 2:, :]
        hs = torch.concatenate([g0, g1, g2, g3], axis=-1) @ w2
        x1 = x + hs
        h2 = _gelu(_layernorm(x1, axis=-1) @ w3) @ w4
        return x1 + h2

    x = A_q
    xn = _layernorm(x, axis=-1)
    return x + _A_ref(xn, A_k, A_v, A_shift_k, A_ssm_k, A_ssm_D) + _B_ref(xn, B_w1, B_w2, B_w3, B_w4)
```

```asm
; @launch grid=(256,1,1) block=(512,1,1) lds=163840
.amdgcn_target "amdgcn-amd-amdhsa--gfx950"
.text
.globl parallel_sum__ssm_conv_h3__mixer_s_mlp__prompt_kernel
.p2align 8
.type parallel_sum__ssm_conv_h3__mixer_s_mlp__prompt_kernel,@function
parallel_sum__ssm_conv_h3__mixer_s_mlp__prompt_kernel:
    s_cmp_ge_u32 s2, 256
    s_cbranch_scc1 L_end
    s_load_dwordx16 s[56:71], s[0:1], 0
    s_load_dwordx8 s[72:79], s[0:1], 64
    s_load_dwordx4 s[80:83], s[0:1], 96
    s_getpc_b64 s[96:97]
L_pc:
    s_lshr_b32 s88, s2, 3
    s_lshl_b32 s88, s88, 10
    s_cmp_ge_u32 s88, L_end-L_pc
    s_cbranch_scc1 L_pf_1
    v_and_b32 v122, 63, v0
    v_lshlrev_b32 v122, 4, v122
    v_add_u32 v122, s88, v122
    v_min_u32 v122, L_end-L_pc-16, v122
    v_cmp_gt_u32 vcc, 64, v0
    s_nop 0
    s_and_saveexec_b64 s[90:91], vcc
    s_nop 1
    s_cbranch_execz L_pf_1_r
    global_load_dwordx4 v[118:121], v122, s[96:97]
L_pf_1_r:
    s_mov_b64 exec, -1
L_pf_1:
    v_lshrrev_b32 v28, 6, v0
    v_and_b32 v1, 63, v0
    v_readfirstlane_b32 s3, v28
    v_and_b32 v2, 15, v0
    v_lshrrev_b32 v3, 4, v1
    v_lshlrev_b32 v4, 4, v1
    s_and_b32 s88, s2, 7
    s_lshl_b32 s88, s88, 2
    s_lshr_b32 s89, s2, 6
    s_add_u32 s4, s88, s89
    s_bfe_u32 s5, s2, 0x30003
    s_lshr_b32 s6, s3, 2
    s_and_b32 s7, s3, 3
    s_lshl_b32 s54, s3, 10
    s_lshl_b32 s88, s5, 7
    s_lshl_b32 s89, s3, 13
    s_add_u32 s55, s88, s89
    s_and_b32 s90, s3, 1
    s_lshl_b32 s90, s90, 2
    v_add_u32 v30, s90, v3
    v_and_b32 v31, 7, v1
    v_xor_b32 v30, v30, v31
    v_lshrrev_b32 v33, 3, v1
    v_lshlrev_b32 v29, 10, v33
    v_lshl_add_u32 v29, v30, 4, v29
    v_bfe_u32 v32, v1, 4, 1
    v_lshlrev_b32 v32, 1, v32
    v_add_u32 v32, s90, v32
    v_xor_b32 v32, v32, v31
    v_lshlrev_b32 v5, 10, v33
    v_lshl_add_u32 v5, v32, 4, v5
    v_mul_u32_u24 v6, 3584, v33
    v_lshl_add_u32 v6, v32, 4, v6
    s_lshl_b32 s97, s4, 16
    s_add_u32 s100, s97, s89
    v_mov_b32 v20, 0x3f803f80
    v_mov_b32 v21, 0x3f803f80
    v_mov_b32 v22, 0x3f803f80
    v_mov_b32 v23, 0x3f803f80
    v_lshrrev_b32 v7, 5, v1
    v_lshlrev_b32 v7, 10, v7
    v_and_b32 v36, 31, v1
    v_lshl_add_u32 v7, v36, 4, v7
    s_waitcnt lgkmcnt(0)
    s_mov_b32 s8, s56
    s_and_b32 s9, s57, 0xffff
    s_mov_b32 s10, 0x200000
    s_mov_b32 s11, 0x20000
    s_mov_b32 s20, s70
    s_and_b32 s21, s71, 0xffff
    s_mov_b32 s22, 0x80000
    s_mov_b32 s23, 0x20000
    s_add_u32 m0, s54, 0
    s_nop 0
    buffer_load_dwordx4 v29, s[8:11], s100 offen  lds
    s_load_dword s52, s[82:83], 0x0
    s_lshl_b32 s88, s5, 7
    s_lshl_b32 s89, s4, 2
    s_add_u32 s88, s88, s89
    s_load_dword s84, s[66:67], s88
    s_mov_b32 s28, s74
    s_and_b32 s29, s75, 0xffff
    s_mov_b32 s30, 0x1c0000
    s_mov_b32 s31, 0x20000
    s_mov_b32 s32, s76
    s_and_b32 s33, s77, 0xffff
    s_add_u32 m0, s54, 8192
    s_add_u32 s95, s100, 128
    buffer_load_dwordx4 v29, s[8:11], s95 offen  lds
    s_mov_b32 s34, 0x1c0000
    s_mov_b32 s35, 0x20000
    s_mov_b32 s40, s82
    s_and_b32 s41, s83, 0xffff
    s_mov_b32 s42, 0x1800000
    s_mov_b32 s43, 0x20000
    s_add_u32 m0, s54, 16384
    s_add_u32 s95, s100, 256
    buffer_load_dwordx4 v29, s[8:11], s95 offen  lds
    s_mov_b32 s12, s58
    s_and_b32 s13, s59, 0xffff
    s_mov_b32 s14, 0x200000
    s_mov_b32 s15, 0x20000
    s_mov_b32 s16, s60
    s_and_b32 s17, s61, 0xffff
    s_add_u32 m0, s54, 24576
    s_add_u32 s95, s100, 384
    buffer_load_dwordx4 v29, s[8:11], s95 offen  lds
    s_mov_b32 s18, 0x200000
    s_mov_b32 s19, 0x20000
    s_mov_b32 s48, s62
    s_and_b32 s49, s63, 0xffff
    s_mov_b32 s50, 0x1000
    s_mov_b32 s51, 0x20000
    s_add_u32 m0, s54, 32768
    s_add_u32 s95, s100, 512
    buffer_load_dwordx4 v29, s[8:11], s95 offen  lds
    s_mov_b32 s24, s72
    s_and_b32 s25, s73, 0xffff
    s_mov_b32 s26, 0x80000
    s_mov_b32 s27, 0x20000
    s_mov_b32 s36, s78
    s_and_b32 s37, s79, 0xffff
    s_add_u32 m0, s54, 40960
    s_add_u32 s95, s100, 640
    buffer_load_dwordx4 v29, s[8:11], s95 offen  lds
    s_mov_b32 s38, 0x200000
    s_mov_b32 s39, 0x20000
    s_mov_b32 s44, s64
    s_and_b32 s45, s65, 0xffff
    s_mov_b32 s46, 0x200000
    s_mov_b32 s47, 0x20000
    s_add_u32 m0, s54, 49152
    s_add_u32 s95, s100, 768
    buffer_load_dwordx4 v29, s[8:11], s95 offen  lds
    s_mov_b32 s79, s97
    s_mov_b32 s80, 0
    s_add_u32 m0, s54, 57344
    s_add_u32 s95, s100, 896
    buffer_load_dwordx4 v29, s[8:11], s95 offen  lds
    s_lshr_b32 s88, s3, 1
    s_and_b32 s89, s3, 1
    s_lshl_b32 s90, s88, 12
    s_lshl_b32 s91, s89, 10
    s_add_u32 s90, s90, s91
    s_cmp_ge_u32 s4, 16
    s_cbranch_scc1 L_pp4_2
    s_mul_i32 s91, s5, 448
    s_and_b32 s93, s5, 1
    s_lshl_b32 s94, s93, 6
    s_sub_u32 s91, s91, s94
    s_lshl_b32 s94, s88, 7
    s_add_u32 s91, s91, s94
    s_lshl_b32 s94, s4, 2
    s_add_u32 s94, s94, s89
    s_mul_i32 s94, s94, 28672
    s_add_u32 s91, s91, s94
    s_add_u32 m0, s90, 147456
    s_nop 0
    buffer_load_dwordx4 v6, s[28:31], s91 offen nt lds
    s_add_u32 m0, s90, 149504
    s_add_u32 s95, s91, 57344
    buffer_load_dwordx4 v6, s[28:31], s95 offen nt lds
    s_lshl_b32 s93, s93, 1
    s_add_u32 s94, s3, s93
    s_lshr_b32 s73, s94, 2
    s_and_b32 s74, s94, 3
    s_add_u32 s94, s94, 8
    s_lshr_b32 s76, s94, 2
    s_and_b32 s76, s76, 3
    s_and_b32 s75, s94, 3
    s_mul_i32 s91, s5, 229376
    s_lshl_b32 s94, s4, 10
    s_add_u32 s91, s91, s94
    s_lshl_b32 s94, s3, 14
    s_add_u32 s91, s91, s94
    s_add_u32 s83, s91, 0x1400000
    s_add_u32 s96, s83, 131072
    s_cmp_ge_u32 s3, 6
    s_cselect_b32 s96, -1, s96
    s_mul_i32 s91, s5, 14336
    s_add_u32 s91, s91, s54
    s_lshl_b32 s94, s4, 6
    s_add_u32 s91, s91, s94
    s_add_u32 s97, s91, 0x520000
    s_branch L_ppj_3
L_pp4_2:
    s_sub_u32 s91, s4, 16
    s_and_b32 s93, s91, 1
    s_lshr_b32 s91, s91, 1
    s_mul_i32 s91, s91, 7
    s_lshl_b32 s94, s93, 2
    s_add_u32 s91, s91, s94
    s_add_u32 s91, s91, s88
    s_min_u32 s91, s91, 55
    s_lshl_b32 s94, s91, 2
    s_add_u32 s94, s94, s89
    s_lshl_b32 s94, s94, 13
    s_lshl_b32 s92, s5, 7
    s_add_u32 s94, s94, s92
    s_add_u32 m0, s90, 147456
    s_nop 0
    buffer_load_dwordx4 v5, s[32:35], s94 offen nt lds
    s_add_u32 m0, s90, 149504
    s_add_u32 s95, s94, 16384
    buffer_load_dwordx4 v5, s[32:35], s95 offen nt lds
    s_mov_b32 s73, s88
    s_mov_b32 s76, s88
    s_lshl_b32 s74, s89, 1
    s_add_u32 s75, s74, 1
    s_mul_i32 s92, s5, 229376
    s_lshl_b32 s94, s91, 10
    s_add_u32 s92, s92, s94
    s_mul_i32 s94, s74, 57344
    s_add_u32 s92, s92, s94
    s_add_u32 s83, s92, 0x1600000
    s_add_u32 s96, s83, 57344
    s_mul_i32 s94, s93, s88
    s_cmp_eq_u32 s94, 3
    s_cselect_b32 s83, -1, s83
    s_cselect_b32 s96, -1, s96
    s_mov_b32 s97, -1
L_ppj_3:
    v_lshrrev_b32 v36, 2, v2
    v_lshl_add_u32 v36, v3, 3, v36
    v_lshlrev_b32 v36, 7, v36
    v_and_b32 v37, 1, v2
    v_lshl_add_u32 v36, v37, 3, v36
    v_add_u32 v36, 65536, v36
    v_bfe_u32 v37, v2, 3, 1
    s_add_u32 m0, s54, 65536
    s_nop 0
    buffer_load_dwordx4 v5, s[20:23], s55 offen  lds
    v_lshlrev_b32 v37, 1, v37
    v_and_b32 v38, 1, v3
    v_lshl_add_u32 v37, v38, 2, v37
    v_bfe_u32 v38, v2, 1, 1
    s_lshl_b32 s88, s7, 1
    v_xor_b32 v24, s88, v37
    v_add_u32 v24, v24, v38
    s_add_u32 m0, s54, 73728
    s_add_u32 s95, s55, 65536
    buffer_load_dwordx4 v5, s[20:23], s95 offen  lds
    v_lshl_add_u32 v24, v24, 4, v36
    s_lshl_b32 s90, s73, 12
    s_add_u32 s90, s90, 81920
    s_lshl_b32 s88, s74, 1
    v_xor_b32 v26, s88, v37
    v_add_u32 v26, v26, v38
    v_lshl_add_u32 v26, v26, 4, v36
    s_add_u32 m0, s54, 81920
    s_add_u32 s95, s55, 131072
    buffer_load_dwordx4 v5, s[20:23], s95 offen  lds
    v_add_u32 v26, s90, v26
    s_lshl_b32 s90, s76, 12
    s_add_u32 s90, s90, 81920
    s_lshl_b32 s88, s75, 1
    v_xor_b32 v27, s88, v37
    v_add_u32 v27, v27, v38
    v_lshl_add_u32 v27, v27, 4, v36
    s_add_u32 m0, s54, 90112
    s_add_u32 s95, s55, 196608
    buffer_load_dwordx4 v5, s[20:23], s95 offen  lds
    v_add_u32 v27, s90, v27
    s_mul_i32 s92, s5, 229376
    s_lshl_b32 s89, s7, 1
    s_add_u32 s89, s89, 0
    s_add_u32 s91, s7, 8
    s_sub_u32 s91, s91, s89
    s_mul_i32 s91, s91, s6
    s_add_u32 m0, s54, 98304
    s_add_u32 s95, s55, 262144
    buffer_load_dwordx4 v5, s[20:23], s95 offen  lds
    s_add_u32 s89, s89, s91
    s_lshl_b32 s89, s89, 14
    s_add_u32 s89, s89, s92
    s_add_u32 s72, s89, 0x1400000
    s_lshl_b32 s89, s7, 1
    s_add_u32 s89, s89, 1
    s_lshr_b32 s91, s7, 1
    s_add_u32 m0, s54, 106496
    s_add_u32 s95, s55, 327680
    buffer_load_dwordx4 v5, s[20:23], s95 offen  lds
    s_add_u32 s91, s91, 12
    s_sub_u32 s91, s91, s89
    s_mul_i32 s91, s91, s6
    s_add_u32 s89, s89, s91
    s_lshl_b32 s89, s89, 14
    s_add_u32 s89, s89, s92
    s_add_u32 s81, s89, 0x1400000
    s_add_u32 m0, s54, 114688
    s_add_u32 s95, s55, 393216
    buffer_load_dwordx4 v5, s[20:23], s95 offen  lds
    s_mul_i32 s89, s7, 57344
    s_and_b32 s91, s7, 1
    s_mul_i32 s91, s91, 14336
    s_add_u32 s89, s89, s91
    s_mul_i32 s91, s6, 28672
    s_add_u32 s89, s89, s91
    s_add_u32 s89, s89, s92
    s_add_u32 m0, s54, 122880
    s_add_u32 s95, s55, 458752
    buffer_load_dwordx4 v5, s[20:23], s95 offen  lds
    s_add_u32 s82, s89, 0x1600000
    s_lshr_b32 s88, s5, 1
    s_lshr_b32 s89, s88, 1
    s_add_u32 s89, s89, 1
    s_and_b32 s88, s88, 1
    s_sub_u32 s90, 0, s89
    s_cmp_eq_u32 s88, 0
    s_cselect_b32 s90, s89, s90
    s_lshl_b32 s91, s4, 6
    s_lshl_b32 s92, s6, 5
    s_add_u32 s91, s91, s92
    s_add_u32 s91, s91, s90
    s_lshl_b32 s92, s5, 1
    s_lshr_b32 s93, s7, 1
    s_add_u32 s92, s92, s93
    s_lshl_b32 s92, s92, 12
    s_and_b32 s93, s7, 1
    s_lshl_b32 s93, s93, 9
    s_add_u32 s92, s92, s93
    s_add_u32 s92, s92, 0x100000
    v_and_b32 v92, 1, v3
    v_lshlrev_b32 v92, 8, v92
    v_add_u32 v92, s92, v92
    v_mov_b32 v93, 0x80000000
    v_lshrrev_b32 v90, 5, v1
    v_lshl_add_u32 v90, v90, 4, v2
    v_add_u32 v91, s91, v90
    v_lshrrev_b32 v88, 6, v91
    v_lshlrev_b32 v88, 16, v88
    v_bfe_u32 v94, v91, 4, 2
    v_lshl_add_u32 v88, v94, 10, v88
    v_and_b32 v94, 15, v91
    v_lshl_add_u32 v88, v94, 4, v88
    v_cmp_gt_u32 vcc, 0x800, v91
    v_add_u32 v88, v88, v92
    s_nop 0
    v_cndmask_b32 v88, v93, v88, vcc
    s_sub_u32 s93, 0x800, s89
    s_cmp_eq_u32 s88, 0
    s_cselect_b32 s93, 0, s93
    s_mul_i32 s94, s88, 31
    s_cmp_eq_u32 s94, s4
    s_cselect_b32 s89, s89, 0
    s_cmp_eq_u32 s88, s6
    s_cselect_b32 s89, s89, 0
    v_add_u32 v91, s93, v2
    v_lshrrev_b32 v89, 6, v91
    v_lshlrev_b32 v89, 16, v89
    v_bfe_u32 v94, v91, 4, 2
    v_lshl_add_u32 v89, v94, 10, v89
    v_and_b32 v94, 15, v91
    v_lshl_add_u32 v89, v94, 4, v89
    v_cmp_gt_u32 vcc, 0x800, v91
    v_add_u32 v89, v89, v92
    s_nop 0
    v_cndmask_b32 v89, v93, v89, vcc
    v_cmp_gt_u32 vcc, s89, v90
    s_nop 1
    v_cndmask_b32 v89, v93, v89, vcc
    s_lshl_b32 s88, s6, 12
    v_lshlrev_b32 v98, 7, v2
    v_add_u32 v98, s88, v98
    v_lshrrev_b32 v99, 1, v2
    v_add_u32 v96, 0, v3
    v_xor_b32 v96, v96, v99
    v_lshl_add_u32 v96, v96, 4, v98
    v_add_u32 v97, 4, v3
    v_xor_b32 v97, v97, v99
    v_lshl_add_u32 v97, v97, 4, v98
    v_mov_b32 v84, 0
    v_mov_b32 v85, 0
    v_mov_b32 v86, 0
    v_mov_b32 v87, 0
    v_lshrrev_b32 v81, 3, v0
    v_lshlrev_b32 v80, 7, v81
    v_and_b32 v82, 7, v0
    v_lshl_add_u32 v80, v82, 13, v80
    v_lshl_add_u32 v80, v82, 4, v80
    v_lshlrev_b32 v81, 4, v81
    v_add_u32 v81, 131072, v81
    v_mov_b32 v32, 0
    v_mov_b32 v33, 0
    v_mov_b32 v34, 0
    v_mov_b32 v35, 0
    s_waitcnt vmcnt(8)
    s_barrier
    s_waitcnt lgkmcnt(0)
    s_add_u32 s52, s52, 1
    s_xor_b32 s53, s52, 0xa5c3f00f
    s_lshl_b32 s88, s84, 16
    s_and_b32 s89, s84, 0xffff0000
    s_cmp_eq_u32 s6, 0
    s_cselect_b32 s84, s88, s89
    ds_read_b64_tr_b16 v[68:69], v26 offset:0
    ds_read_b64_tr_b16 v[70:71], v26 offset:512
    ds_read_b64_tr_b16 v[72:73], v27 offset:0
    ds_read_b64_tr_b16 v[74:75], v27 offset:512
    v_xor_b32 v31, 0, v80
    ds_read_b128 v[36:39], v31
    v_xor_b32 v31, 16, v80
    ds_read_b128 v[40:43], v31
    v_xor_b32 v31, 32, v80
    ds_read_b128 v[44:47], v31
    v_xor_b32 v31, 48, v80
    ds_read_b128 v[48:51], v31
    v_xor_b32 v31, 64, v80
    ds_read_b128 v[52:55], v31
    v_xor_b32 v31, 80, v80
    ds_read_b128 v[56:59], v31
    v_xor_b32 v31, 96, v80
    ds_read_b128 v[60:63], v31
    v_xor_b32 v31, 112, v80
    ds_read_b128 v[64:67], v31
    s_waitcnt lgkmcnt(6)
    v_dot2_f32_bf16 v32, v36, v20, v32
    v_dot2_f32_bf16 v34, v36, v36, v34
    v_dot2_f32_bf16 v33, v37, v20, v33
    v_dot2_f32_bf16 v35, v37, v37, v35
    v_dot2_f32_bf16 v32, v38, v20, v32
    v_dot2_f32_bf16 v34, v38, v38, v34
    v_dot2_f32_bf16 v33, v39, v20, v33
    v_dot2_f32_bf16 v35, v39, v39, v35
    v_dot2_f32_bf16 v32, v40, v20, v32
    v_dot2_f32_bf16 v34, v40, v40, v34
    v_dot2_f32_bf16 v33, v41, v20, v33
    v_dot2_f32_bf16 v35, v41, v41, v35
    v_dot2_f32_bf16 v32, v42, v20, v32
    v_dot2_f32_bf16 v34, v42, v42, v34
    v_dot2_f32_bf16 v33, v43, v20, v33
    v_dot2_f32_bf16 v35, v43, v43, v35
    s_waitcnt lgkmcnt(4)
    v_dot2_f32_bf16 v32, v44, v20, v32
    v_dot2_f32_bf16 v34, v44, v44, v34
    v_dot2_f32_bf16 v33, v45, v20, v33
    v_dot2_f32_bf16 v35, v45, v45, v35
    v_dot2_f32_bf16 v32, v46, v20, v32
    v_dot2_f32_bf16 v34, v46, v46, v34
    v_dot2_f32_bf16 v33, v47, v20, v33
    v_dot2_f32_bf16 v35, v47, v47, v35
    v_dot2_f32_bf16 v32, v48, v20, v32
    v_dot2_f32_bf16 v34, v48, v48, v34
    v_dot2_f32_bf16 v33, v49, v20, v33
    v_dot2_f32_bf16 v35, v49, v49, v35
    v_dot2_f32_bf16 v32, v50, v20, v32
    v_dot2_f32_bf16 v34, v50, v50, v34
    v_dot2_f32_bf16 v33, v51, v20, v33
    v_dot2_f32_bf16 v35, v51, v51, v35
    s_waitcnt lgkmcnt(2)
    v_dot2_f32_bf16 v32, v52, v20, v32
    v_dot2_f32_bf16 v34, v52, v52, v34
    v_dot2_f32_bf16 v33, v53, v20, v33
    v_dot2_f32_bf16 v35, v53, v53, v35
    v_dot2_f32_bf16 v32, v54, v20, v32
    v_dot2_f32_bf16 v34, v54, v54, v34
    v_dot2_f32_bf16 v33, v55, v20, v33
    v_dot2_f32_bf16 v35, v55, v55, v35
    v_dot2_f32_bf16 v32, v56, v20, v32
    v_dot2_f32_bf16 v34, v56, v56, v34
    v_dot2_f32_bf16 v33, v57, v20, v33
    v_dot2_f32_bf16 v35, v57, v57, v35
    v_dot2_f32_bf16 v32, v58, v20, v32
    v_dot2_f32_bf16 v34, v58, v58, v34
    v_dot2_f32_bf16 v33, v59, v20, v33
    v_dot2_f32_bf16 v35, v59, v59, v35
    s_waitcnt lgkmcnt(0)
    v_dot2_f32_bf16 v32, v60, v20, v32
    v_dot2_f32_bf16 v34, v60, v60, v34
    v_dot2_f32_bf16 v33, v61, v20, v33
    v_dot2_f32_bf16 v35, v61, v61, v35
    v_dot2_f32_bf16 v32, v62, v20, v32
    v_dot2_f32_bf16 v34, v62, v62, v34
    v_dot2_f32_bf16 v33, v63, v20, v33
    v_dot2_f32_bf16 v35, v63, v63, v35
    v_dot2_f32_bf16 v32, v64, v20, v32
    v_dot2_f32_bf16 v34, v64, v64, v34
    v_dot2_f32_bf16 v33, v65, v20, v33
    v_dot2_f32_bf16 v35, v65, v65, v35
    v_dot2_f32_bf16 v32, v66, v20, v32
    v_dot2_f32_bf16 v34, v66, v66, v34
    v_dot2_f32_bf16 v33, v67, v20, v33
    v_dot2_f32_bf16 v35, v67, v67, v35
    s_nop 1
    v_add_f32 v32, v32, v33
    v_add_f32 v34, v34, v35
    s_nop 0
    v_add_f32_dpp v32, v32, v32 quad_perm:[1,0,3,2] row_mask:0xf bank_mask:0xf
    v_add_f32_dpp v34, v34, v34 quad_perm:[1,0,3,2] row_mask:0xf bank_mask:0xf
    s_nop 0
    v_add_f32_dpp v32, v32, v32 quad_perm:[2,3,0,1] row_mask:0xf bank_mask:0xf
    v_add_f32_dpp v34, v34, v34 quad_perm:[2,3,0,1] row_mask:0xf bank_mask:0xf
    s_nop 0
    v_add_f32_dpp v32, v32, v32 row_half_mirror row_mask:0xf bank_mask:0xf
    v_add_f32_dpp v34, v34, v34 row_half_mirror row_mask:0xf bank_mask:0xf
    v_mul_f32 v36, 0x3b000000, v32
    v_mul_f32 v40, 0x3b000000, v34
    v_fma_f32 v40, -v36, v36, v40
    v_max_f32 v40, 0, v40
    v_add_f32 v41, 0x3727c5ac, v40
    v_rsq_f32 v37, v41
    s_nop 0
    v_mul_f32 v42, v37, v37
    v_mul_f32 v42, v42, v40
    v_add_f32 v42, 0x3727c5ac, v42
    v_rsq_f32 v43, v42
    s_nop 0
    v_mul_f32 v38, v37, v43
    v_rcp_f32 v39, v38
    s_mov_b32 s88, 0x01010101
    s_mov_b32 s89, 0x01010101
    s_mov_b64 exec, s[88:89]
    ds_write_b128 v81, v[36:39]
    s_mov_b64 exec, -1
    s_cmp_eq_u32 s83, -1
    s_cselect_b32 s88, 0x80000000, 0
    s_cselect_b32 s83, 0, s83
    v_or_b32 v48, s88, v4
    s_cmp_eq_u32 s96, -1
    s_cselect_b32 s88, 0x80000000, 0
    s_cselect_b32 s96, 0, s96
    v_or_b32 v49, s88, v4
    s_mov_b32 s89, s88
    s_cmp_eq_u32 s97, -1
    s_cselect_b32 s88, 0x80000000, 0
    s_cselect_b32 s97, 0, s97
    s_or_b32 s89, s89, s88
    v_lshlrev_b32 v46, 2, v2
    v_or_b32 v50, s88, v46
    v_or_b32 v51, s89, v46
    buffer_store_dwordx4 v[68:71], v48, s[40:43], s83 offen sc0 sc1
    buffer_store_dwordx4 v[72:75], v49, s[40:43], s96 offen sc0 sc1
    v_mov_b32 v44, 0
    v_mov_b32 v45, 0
    v_dot2_f32_bf16 v44, v68, v20, v44
    v_dot2_f32_bf16 v45, v72, v20, v45
    v_dot2_f32_bf16 v44, v69, v20, v44
    v_dot2_f32_bf16 v45, v73, v20, v45
    v_dot2_f32_bf16 v44, v70, v20, v44
    v_dot2_f32_bf16 v45, v74, v20, v45
    v_dot2_f32_bf16 v44, v71, v20, v44
    v_dot2_f32_bf16 v45, v75, v20, v45
    s_nop 1
    v_mov_b32 v46, v44
    v_mov_b32 v47, v45
    s_nop 0
    v_permlane32_swap_b32 v44, v46
    v_permlane32_swap_b32 v45, v47
    v_add_f32 v44, v44, v46
    v_add_f32 v45, v45, v47
    v_mov_b32 v46, v44
    v_mov_b32 v47, v45
    s_nop 0
    v_permlane16_swap_b32 v44, v46
    v_permlane16_swap_b32 v45, v47
    v_add_f32 v44, v44, v46
    v_add_f32 v45, v45, v47
    s_add_u32 s95, s97, 8192
    s_mov_b64 exec, 0xffff
    buffer_store_dword v44, v50, s[40:43], s97 offen sc0 sc1
    buffer_store_dword v45, v51, s[40:43], s95 offen sc0 sc1
    s_mov_b64 exec, -1
    s_waitcnt vmcnt(4)
    s_waitcnt lgkmcnt(0)
    s_barrier
    ds_read_b64_tr_b16 a[0:1], v24 offset:0
    ds_read_b64_tr_b16 a[2:3], v24 offset:512
    ds_read_b64_tr_b16 a[4:5], v24 offset:4096
    ds_read_b64_tr_b16 a[6:7], v24 offset:4608
    ds_read_b64_tr_b16 a[8:9], v24 offset:8192
    ds_read_b64_tr_b16 a[10:11], v24 offset:8704
    ds_read_b128 v[40:43], v96 offset:0
    ds_read_b128 v[44:47], v96 offset:2048
    ds_read_b64_tr_b16 a[12:13], v24 offset:12288
    ds_read_b64_tr_b16 a[14:15], v24 offset:12800
    ds_read_b128 v[48:51], v97 offset:0
    ds_read_b128 v[52:55], v97 offset:2048
    s_waitcnt lgkmcnt(10)
    v_mfma_f32_16x16x32_bf16 v[36:39], a[0:3], v[20:23], 0
    s_waitcnt lgkmcnt(4)
    v_mfma_f32_16x16x32_bf16 v[28:31], a[0:3], v[40:43], 0
    v_mfma_f32_16x16x32_bf16 v[32:35], a[0:3], v[44:47], 0
    ds_read_b64_tr_b16 a[16:17], v24 offset:16384
    ds_read_b64_tr_b16 a[18:19], v24 offset:16896
    ds_read_b128 v[40:43], v96 offset:8192
    ds_read_b128 v[44:47], v96 offset:10240
    v_mfma_f32_16x16x32_bf16 v[36:39], a[4:7], v[20:23], v[36:39]
    s_waitcnt lgkmcnt(4)
    v_mfma_f32_16x16x32_bf16 v[28:31], a[4:7], v[48:51], v[28:31]
    v_mfma_f32_16x16x32_bf16 v[32:35], a[4:7], v[52:55], v[32:35]
    s_lshl_b32 s88, s6, 9
    s_add_u32 s88, s88, 131072
    v_lshlrev_b32 v76, 4, v2
    v_add_u32 v76, s88, v76
    ds_read_b128 v[68:71], v76
    ds_read_b128 v[72:75], v76 offset:256
    ds_read_b64_tr_b16 a[20:21], v24 offset:20480
    ds_read_b64_tr_b16 a[22:23], v24 offset:20992
    ds_read_b128 v[48:51], v97 offset:8192
    ds_read_b128 v[52:55], v97 offset:10240
    v_mfma_f32_16x16x32_bf16 v[36:39], a[8:11], v[20:23], v[36:39]
    s_waitcnt lgkmcnt(6)
    v_mfma_f32_16x16x32_bf16 v[28:31], a[8:11], v[40:43], v[28:31]
    v_mfma_f32_16x16x32_bf16 v[32:35], a[8:11], v[44:47], v[32:35]
    v_lshrrev_b32 v104, 3, v1
    v_lshlrev_b32 v104, 10, v104
    v_and_b32 v105, 7, v1
    v_lshl_add_u32 v104, v105, 4, v104
    s_lshl_b32 s88, s5, 7
    s_add_u32 s88, s88, s79
    s_lshl_b32 s89, s3, 13
    s_add_u32 s77, s88, s89
    s_cmp_eq_u32 s4, 0
    s_cselect_b32 s89, 0x80000000, 0
    s_sub_u32 s90, s88, 0x2000
    s_cmp_eq_u32 s4, 0
    s_cselect_b32 s78, 0, s90
    v_or_b32 v105, s89, v104
    v_and_b32 v106, 31, v0
    v_lshlrev_b32 v106, 4, v106
    s_lshl_b32 s89, s5, 9
    v_add_u32 v106, s89, v106
    ds_read_b64_tr_b16 a[24:25], v24 offset:24576
    ds_read_b64_tr_b16 a[26:27], v24 offset:25088
    ds_read_b128 v[40:43], v96 offset:16384
    ds_read_b128 v[44:47], v96 offset:18432
    v_mfma_f32_16x16x32_bf16 v[36:39], a[12:15], v[20:23], v[36:39]
    s_waitcnt lgkmcnt(4)
    v_mfma_f32_16x16x32_bf16 v[28:31], a[12:15], v[48:51], v[28:31]
    v_mfma_f32_16x16x32_bf16 v[32:35], a[12:15], v[52:55], v[32:35]
    s_add_u32 m0, s54, 133120
    s_nop 0
    buffer_load_dwordx4 v104, s[12:15], s77 offen nt lds
    ds_read_b64_tr_b16 a[28:29], v24 offset:28672
    ds_read_b64_tr_b16 a[30:31], v24 offset:29184
    ds_read_b128 v[48:51], v97 offset:16384
    ds_read_b128 v[52:55], v97 offset:18432
    v_mfma_f32_16x16x32_bf16 v[36:39], a[16:19], v[20:23], v[36:39]
    s_waitcnt lgkmcnt(4)
    v_mfma_f32_16x16x32_bf16 v[28:31], a[16:19], v[40:43], v[28:31]
    v_mfma_f32_16x16x32_bf16 v[32:35], a[16:19], v[44:47], v[32:35]
    ds_read_b64_tr_b16 a[32:33], v24 offset:32768
    ds_read_b64_tr_b16 a[34:35], v24 offset:33280
    ds_read_b128 v[40:43], v96 offset:24576
    ds_read_b128 v[44:47], v96 offset:26624
    v_mfma_f32_16x16x32_bf16 v[36:39], a[20:23], v[20:23], v[36:39]
    s_waitcnt lgkmcnt(4)
    v_mfma_f32_16x16x32_bf16 v[28:31], a[20:23], v[48:51], v[28:31]
    v_mfma_f32_16x16x32_bf16 v[32:35], a[20:23], v[52:55], v[32:35]
    s_add_u32 m0, s54, 141312
    s_nop 0
    buffer_load_dwordx4 v104, s[16:19], s77 offen nt lds
    ds_read_b64_tr_b16 a[36:37], v24 offset:36864
    ds_read_b64_tr_b16 a[38:39], v24 offset:37376
    ds_read_b128 v[48:51], v97 offset:24576
    ds_read_b128 v[52:55], v97 offset:26624
    v_mfma_f32_16x16x32_bf16 v[36:39], a[24:27], v[20:23], v[36:39]
    s_waitcnt lgkmcnt(4)
    v_mfma_f32_16x16x32_bf16 v[28:31], a[24:27], v[40:43], v[28:31]
    v_mfma_f32_16x16x32_bf16 v[32:35], a[24:27], v[44:47], v[32:35]
    ds_read_b64_tr_b16 a[40:41], v24 offset:40960
    ds_read_b64_tr_b16 a[42:43], v24 offset:41472
    ds_read_b128 v[40:43], v96 offset:32768
    ds_read_b128 v[44:47], v96 offset:34816
    v_mfma_f32_16x16x32_bf16 v[36:39], a[28:31], v[20:23], v[36:39]
    s_waitcnt lgkmcnt(4)
    v_mfma_f32_16x16x32_bf16 v[28:31], a[28:31], v[48:51], v[28:31]
    v_mfma_f32_16x16x32_bf16 v[32:35], a[28:31], v[52:55], v[32:35]
    buffer_load_dwordx4 v[112:115], v106, s[48:51], 0 offen
    ds_read_b64_tr_b16 a[44:45], v24 offset:45056
    ds_read_b64_tr_b16 a[46:47], v24 offset:45568
    ds_read_b128 v[48:51], v97 offset:32768
    ds_read_b128 v[52:55], v97 offset:34816
    v_mfma_f32_16x16x32_bf16 v[36:39], a[32:35], v[20:23], v[36:39]
    s_waitcnt lgkmcnt(4)
    v_mfma_f32_16x16x32_bf16 v[28:31], a[32:35], v[40:43], v[28:31]
    v_mfma_f32_16x16x32_bf16 v[32:35], a[32:35], v[44:47], v[32:35]
    ds_read_b64_tr_b16 a[48:49], v24 offset:49152
    ds_read_b64_tr_b16 a[50:51], v24 offset:49664
    ds_read_b128 v[40:43], v96 offset:40960
    ds_read_b128 v[44:47], v96 offset:43008
    v_mfma_f32_16x16x32_bf16 v[36:39], a[36:39], v[20:23], v[36:39]
    s_waitcnt lgkmcnt(4)
    v_mfma_f32_16x16x32_bf16 v[28:31], a[36:39], v[48:51], v[28:31]
    v_mfma_f32_16x16x32_bf16 v[32:35], a[36:39], v[52:55], v[32:35]
    v_sub_f32 v76, 0, v68
    v_mul_f32 v77, 0xc0135761, v70
    v_mul_f32 v78, v70, v70
    v_mul_f32 v78, v78, v70
    v_mul_f32 v78, 0xbdd2d3e8, v78
    v_mov_b32 v79, v71
    s_mov_b32 m0, 132096
    s_nop 0
    buffer_load_dwordx4 v105, s[12:15], s78 offen nt lds
    ds_read_b64_tr_b16 a[52:53], v24 offset:53248
    ds_read_b64_tr_b16 a[54:55], v24 offset:53760
    ds_read_b128 v[48:51], v97 offset:40960
    ds_read_b128 v[52:55], v97 offset:43008
    v_mfma_f32_16x16x32_bf16 v[36:39], a[40:43], v[20:23], v[36:39]
    s_waitcnt lgkmcnt(4)
    v_mfma_f32_16x16x32_bf16 v[28:31], a[40:43], v[40:43], v[28:31]
    v_mfma_f32_16x16x32_bf16 v[32:35], a[40:43], v[44:47], v[32:35]
    v_sub_f32 v80, 0, v72
    v_mul_f32 v81, 0xc0135761, v74
    v_mul_f32 v82, v74, v74
    v_mul_f32 v82, v82, v74
    v_mul_f32 v82, 0xbdd2d3e8, v82
    v_mov_b32 v83, v75
    ds_read_b64_tr_b16 a[56:57], v24 offset:57344
    ds_read_b64_tr_b16 a[58:59], v24 offset:57856
    ds_read_b128 v[40:43], v96 offset:49152
    ds_read_b128 v[44:47], v96 offset:51200
    v_mfma_f32_16x16x32_bf16 v[36:39], a[44:47], v[20:23], v[36:39]
    s_waitcnt lgkmcnt(4)
    v_mfma_f32_16x16x32_bf16 v[28:31], a[44:47], v[48:51], v[28:31]
    v_mfma_f32_16x16x32_bf16 v[32:35], a[44:47], v[52:55], v[32:35]
    ds_read_b64_tr_b16 a[60:61], v24 offset:61440
    ds_read_b64_tr_b16 a[62:63], v24 offset:61952
    ds_read_b128 v[48:51], v97 offset:49152
    ds_read_b128 v[52:55], v97 offset:51200
    v_mfma_f32_16x16x32_bf16 v[36:39], a[48:51], v[20:23], v[36:39]
    s_waitcnt lgkmcnt(4)
    v_mfma_f32_16x16x32_bf16 v[28:31], a[48:51], v[40:43], v[28:31]
    v_mfma_f32_16x16x32_bf16 v[32:35], a[48:51], v[44:47], v[32:35]
    s_waitcnt lgkmcnt(0)
    s_barrier
    ds_read_b128 v[40:43], v96 offset:57344
    ds_read_b128 v[44:47], v96 offset:59392
    v_mfma_f32_16x16x32_bf16 v[36:39], a[52:55], v[20:23], v[36:39]
    v_mfma_f32_16x16x32_bf16 v[28:31], a[52:55], v[48:51], v[28:31]
    v_mfma_f32_16x16x32_bf16 v[32:35], a[52:55], v[52:55], v[32:35]
    ds_read_b128 v[48:51], v97 offset:57344
    ds_read_b128 v[52:55], v97 offset:59392
    v_mfma_f32_16x16x32_bf16 v[36:39], a[56:59], v[20:23], v[36:39]
    s_waitcnt lgkmcnt(2)
    v_mfma_f32_16x16x32_bf16 v[28:31], a[56:59], v[40:43], v[28:31]
    v_mfma_f32_16x16x32_bf16 v[32:35], a[56:59], v[44:47], v[32:35]
    v_mfma_f32_16x16x32_bf16 v[36:39], a[60:63], v[20:23], v[36:39]
    s_waitcnt lgkmcnt(0)
    v_mfma_f32_16x16x32_bf16 v[28:31], a[60:63], v[48:51], v[28:31]
    v_mfma_f32_16x16x32_bf16 v[32:35], a[60:63], v[52:55], v[32:35]
    s_nop 6
    v_fma_f32 v28, v36, v76, v28
    v_fma_f32 v29, v37, v76, v29
    v_fma_f32 v30, v38, v76, v30
    v_fma_f32 v31, v39, v76, v31
    v_pk_mul_f32 v[92:93], v[28:29], v[28:29]
    v_pk_mul_f32 v[94:95], v[30:31], v[30:31]
    v_fma_f32 v92, v92, v78, v77
    v_fma_f32 v93, v93, v78, v77
    v_fma_f32 v94, v94, v78, v77
    v_fma_f32 v95, v95, v78, v77
    v_pk_mul_f32 v[92:93], v[92:93], v[28:29]
    v_pk_mul_f32 v[94:95], v[94:95], v[30:31]
    v_exp_f32 v92, v92
    v_exp_f32 v93, v93
    v_exp_f32 v94, v94
    v_exp_f32 v95, v95
    v_fma_f32 v92, v92, v79, v79
    v_fma_f32 v93, v93, v79, v79
    v_fma_f32 v94, v94, v79, v79
    v_fma_f32 v95, v95, v79, v79
    v_rcp_f32 v92, v92
    v_rcp_f32 v93, v93
    v_rcp_f32 v94, v94
    v_rcp_f32 v95, v95
    v_pk_mul_f32 v[28:29], v[28:29], v[92:93]
    v_pk_mul_f32 v[30:31], v[30:31], v[94:95]
    v_fma_f32 v32, v36, v80, v32
    v_fma_f32 v33, v37, v80, v33
    v_fma_f32 v34, v38, v80, v34
    v_fma_f32 v35, v39, v80, v35
    v_pk_mul_f32 v[96:97], v[32:33], v[32:33]
    v_pk_mul_f32 v[98:99], v[34:35], v[34:35]
    v_fma_f32 v96, v96, v82, v81
    v_fma_f32 v97, v97, v82, v81
    v_fma_f32 v98, v98, v82, v81
    v_fma_f32 v99, v99, v82, v81
    v_pk_mul_f32 v[96:97], v[96:97], v[32:33]
    v_pk_mul_f32 v[98:99], v[98:99], v[34:35]
    v_exp_f32 v96, v96
    v_exp_f32 v97, v97
    v_exp_f32 v98, v98
    v_exp_f32 v99, v99
    v_fma_f32 v96, v96, v83, v83
    v_fma_f32 v97, v97, v83, v83
    v_fma_f32 v98, v98, v83, v83
    v_fma_f32 v99, v99, v83, v83
    v_rcp_f32 v96, v96
    v_rcp_f32 v97, v97
    v_rcp_f32 v98, v98
    v_rcp_f32 v99, v99
    v_pk_mul_f32 v[32:33], v[32:33], v[96:97]
    v_pk_mul_f32 v[34:35], v[34:35], v[98:99]
    v_cvt_pk_bf16_f32 v100, v28, v29
    v_cvt_pk_bf16_f32 v101, v30, v31
    v_cvt_pk_bf16_f32 v102, v32, v33
    v_cvt_pk_bf16_f32 v103, v34, v35
    s_nop 0
    v_permlane32_swap_b32 v100, v102
    v_permlane32_swap_b32 v101, v103
    s_nop 0
    v_permlane16_swap_b32 v100, v102
    v_permlane16_swap_b32 v101, v103
    buffer_store_dwordx4 v[100:103], v88, s[40:43], 0 offen sc0 sc1
    buffer_store_dwordx4 v[84:87], v89, s[40:43], 0 offen sc0 sc1
    s_add_u32 m0, s54, 65536
    s_nop 0
    buffer_load_dwordx4 v5, s[24:27], s55 offen  lds
    s_add_u32 m0, s54, 73728
    s_add_u32 s95, s55, 65536
    buffer_load_dwordx4 v5, s[24:27], s95 offen  lds
    s_add_u32 m0, s54, 81920
    s_add_u32 s95, s55, 131072
    buffer_load_dwordx4 v5, s[24:27], s95 offen  lds
    s_lshl_b32 s88, s5, 13
    s_lshl_b32 s89, s6, 12
    s_add_u32 s88, s88, s89
    v_lshlrev_b32 v29, 7, v2
    v_add_u32 v29, s88, v29
    v_and_b32 v30, 1, v3
    v_lshl_add_u32 v29, v30, 3, v29
    v_lshrrev_b32 v30, 1, v3
    s_lshl_b32 s89, s7, 1
    v_add_u32 v30, s89, v30
    v_lshrrev_b32 v31, 1, v2
    v_xor_b32 v30, v30, v31
    v_lshl_add_u32 v33, v30, 4, v29
    ds_read_b64 v[8:9], v33 offset:0
    ds_read_b64 v[10:11], v33 offset:2048
    s_waitcnt lgkmcnt(0)
    v_lshlrev_b32 v36, 16, v8
    v_and_b32 v37, 0xffff0000, v8
    v_lshlrev_b32 v38, 16, v9
    v_and_b32 v39, 0xffff0000, v9
    v_lshlrev_b32 v40, 16, v10
    v_and_b32 v41, 0xffff0000, v10
    v_lshlrev_b32 v42, 16, v11
    v_and_b32 v43, 0xffff0000, v11
    v_sub_f32 v36, v36, v68
    v_sub_f32 v37, v37, v68
    v_sub_f32 v38, v38, v68
    v_sub_f32 v39, v39, v68
    v_sub_f32 v40, v40, v72
    v_sub_f32 v41, v41, v72
    v_sub_f32 v42, v42, v72
    v_sub_f32 v43, v43, v72
    v_mul_f32 v36, v36, v69
    v_mul_f32 v37, v37, v69
    v_mul_f32 v38, v38, v69
    v_mul_f32 v39, v39, v69
    v_mul_f32 v40, v40, v73
    v_mul_f32 v41, v41, v73
    v_mul_f32 v42, v42, v73
    v_mul_f32 v43, v43, v73
    v_cvt_pk_bf16_f32 v12, v36, v37
    v_cvt_pk_bf16_f32 v13, v38, v39
    v_cvt_pk_bf16_f32 v14, v40, v41
    v_cvt_pk_bf16_f32 v15, v42, v43
    s_waitcnt vmcnt(3)
    s_barrier
    s_cmp_lg_u32 s3, 0
    s_cbranch_scc1 L_sig_4
    s_add_u32 s88, s4, 1
    s_lshl_b32 s88, s88, 6
    s_lshl_b32 s89, s5, 3
    s_add_u32 s88, s88, s89
    s_add_u32 s88, s88, 0x2000
    v_mov_b32 v108, s52
    s_getreg_b32 s89, hwreg(HW_REG_XCC_ID, 0, 4)
    s_xor_b32 s89, s89, s53
    v_mov_b32 v109, s89
    v_mov_b32 v110, s88
    s_mov_b64 exec, 1
    buffer_store_dwordx2 v[108:109], v110, s[40:43], 0 offen sc0 sc1
    s_mov_b64 exec, -1
L_sig_4:
    s_cmp_lg_u32 s3, 0
    s_cbranch_scc1 L_sig_5
    s_lshl_b32 s88, s5, 8
    s_lshl_b32 s89, s4, 3
    s_add_u32 s88, s88, s89
    s_add_u32 s88, s88, 0x6000
    v_mov_b32 v108, s52
    v_mov_b32 v109, s53
    v_mov_b32 v110, s88
    s_mov_b64 exec, 1
    buffer_store_dwordx2 v[108:109], v110, s[40:43], 0 offen sc0 sc1
    s_mov_b64 exec, -1
L_sig_5:
    s_add_u32 s97, s4, s5
    s_and_b32 s97, s97, 3
    s_lshl_b32 s97, s97, 12
    v_lshrrev_b32 v51, 5, v0
    v_lshlrev_b32 v51, 9, v51
    v_and_b32 v52, 31, v0
    v_lshl_add_u32 v51, v52, 2, v51
    v_add_u32 v51, 132736, v51
    ds_read_b32 v60, v51 offset:0
    ds_read_b32 v61, v51 offset:128
    ds_read_b32 v62, v51 offset:256
    ds_read_b32 v63, v51 offset:384
    ds_read_b32 v64, v51 offset:512
    ds_read_b32 v65, v51 offset:640
    ds_read_b32 v66, v51 offset:768
    ds_read_b32 v68, v51 offset:8576
    ds_read_b32 v69, v51 offset:8704
    ds_read_b32 v70, v51 offset:8832
    ds_read_b32 v71, v51 offset:8960
    v_lshrrev_b32 v48, 5, v0
    v_sub_u32 v48, 15, v48
    v_lshlrev_b32 v48, 3, v48
    s_add_u32 m0, s54, 90112
    s_add_u32 s95, s55, 196608
    buffer_load_dwordx4 v5, s[24:27], s95 offen  lds
    v_and_b32 v49, 31, v0
    v_mul_u32_u24 v49, 288, v49
    v_add3_u32 v48, v48, v49, 0
    s_add_u32 m0, s54, 98304
    s_add_u32 s95, s55, 262144
    buffer_load_dwordx4 v5, s[24:27], s95 offen  lds
    s_waitcnt lgkmcnt(0)
    v_lshlrev_b32 v28, 16, v60
    v_lshlrev_b32 v29, 16, v61
    v_lshlrev_b32 v30, 16, v62
    v_lshlrev_b32 v31, 16, v63
    v_lshlrev_b32 v32, 16, v64
    v_lshlrev_b32 v33, 16, v65
    v_lshlrev_b32 v34, 16, v66
    v_lshlrev_b32 v36, 16, v112
    s_add_u32 m0, s54, 106496
    s_add_u32 s95, s55, 327680
    buffer_load_dwordx4 v5, s[24:27], s95 offen  lds
    v_and_b32 v37, 0xffff0000, v112
    v_lshlrev_b32 v38, 16, v113
    v_and_b32 v39, 0xffff0000, v113
    v_mul_f32 v40, v39, v28
    v_mul_f32 v41, v39, v29
    v_mul_f32 v42, v39, v30
    v_mul_f32 v43, v39, v31
    v_fmac_f32 v40, v38, v29
    s_add_u32 m0, s54, 114688
    s_add_u32 s95, s55, 393216
    buffer_load_dwordx4 v5, s[24:27], s95 offen  lds
    v_fmac_f32 v41, v38, v30
    v_fmac_f32 v42, v38, v31
    v_fmac_f32 v43, v38, v32
    v_fmac_f32 v40, v37, v30
    v_fmac_f32 v41, v37, v31
    v_fmac_f32 v42, v37, v32
    v_fmac_f32 v43, v37, v33
    v_fmac_f32 v40, v36, v31
    s_add_u32 m0, s54, 122880
    s_add_u32 s95, s55, 458752
    buffer_load_dwordx4 v5, s[24:27], s95 offen  lds
    v_fmac_f32 v41, v36, v32
    v_fmac_f32 v42, v36, v33
    v_fmac_f32 v43, v36, v34
    v_lshlrev_b32 v28, 16, v68
    v_lshlrev_b32 v29, 16, v69
    v_lshlrev_b32 v30, 16, v70
    v_lshlrev_b32 v31, 16, v71
    v_mul_f32 v40, v40, v28
    v_mul_f32 v41, v41, v29
    v_mul_f32 v42, v42, v30
    v_mul_f32 v43, v43, v31
    v_cvt_pk_bf16_f32 v44, v43, v42
    v_cvt_pk_bf16_f32 v45, v41, v40
    ds_write_b64 v48, v[44:45] offset:0
    v_and_b32 v28, 0xffff0000, v60
    v_and_b32 v29, 0xffff0000, v61
    v_and_b32 v30, 0xffff0000, v62
    v_and_b32 v31, 0xffff0000, v63
    v_and_b32 v32, 0xffff0000, v64
    v_and_b32 v33, 0xffff0000, v65
    v_and_b32 v34, 0xffff0000, v66
    v_lshlrev_b32 v36, 16, v114
    v_and_b32 v37, 0xffff0000, v114
    v_lshlrev_b32 v38, 16, v115
    v_and_b32 v39, 0xffff0000, v115
    v_mul_f32 v40, v39, v28
    v_mul_f32 v41, v39, v29
    v_mul_f32 v42, v39, v30
    v_mul_f32 v43, v39, v31
    v_fmac_f32 v40, v38, v29
    v_fmac_f32 v41, v38, v30
    v_fmac_f32 v42, v38, v31
    v_fmac_f32 v43, v38, v32
    v_fmac_f32 v40, v37, v30
    v_fmac_f32 v41, v37, v31
    v_fmac_f32 v42, v37, v32
    v_fmac_f32 v43, v37, v33
    v_fmac_f32 v40, v36, v31
    v_fmac_f32 v41, v36, v32
    v_fmac_f32 v42, v36, v33
    v_fmac_f32 v43, v36, v34
    v_and_b32 v28, 0xffff0000, v68
    v_and_b32 v29, 0xffff0000, v69
    v_and_b32 v30, 0xffff0000, v70
    v_and_b32 v31, 0xffff0000, v71
    v_mul_f32 v40, v40, v28
    v_mul_f32 v41, v41, v29
    v_mul_f32 v42, v42, v30
    v_mul_f32 v43, v43, v31
    v_cvt_pk_bf16_f32 v46, v43, v42
    v_cvt_pk_bf16_f32 v47, v41, v40
    ds_write_b64 v48, v[46:47] offset:144
    v_lshrrev_b32 v48, 3, v0
    v_and_b32 v49, 7, v0
    v_lshlrev_b32 v49, 4, v49
    v_mul_u32_u24 v50, 144, v48
    v_add3_u32 v50, v50, v49, 0
    v_lshlrev_b32 v48, 12, v48
    v_add_u32 v48, v48, v49
    s_waitcnt lgkmcnt(0)
    s_barrier
    s_lshl_b32 s88, s5, 18
    s_lshl_b32 s89, s4, 7
    s_sub_u32 s88, s88, s89
    s_add_u32 s88, s88, 0x600f80
    ds_read_b128 v[40:43], v50
    s_waitcnt lgkmcnt(0)
    buffer_store_dwordx4 v[40:43], v48, s[40:43], s88 offen sc0 sc1
    s_waitcnt vmcnt(1)
    s_barrier
    ds_read_b64_tr_b16 a[64:65], v24 offset:0
    ds_read_b64_tr_b16 a[66:67], v24 offset:512
    ds_read_b64_tr_b16 a[68:69], v24 offset:4096
    ds_read_b64_tr_b16 a[70:71], v24 offset:4608
    ds_read_b64_tr_b16 a[72:73], v24 offset:8192
    ds_read_b64_tr_b16 a[74:75], v24 offset:8704
    ds_read_b64_tr_b16 a[76:77], v24 offset:12288
    ds_read_b64_tr_b16 a[78:79], v24 offset:12800
    ds_read_b64_tr_b16 a[80:81], v24 offset:16384
    ds_read_b64_tr_b16 a[82:83], v24 offset:16896
    ds_read_b64_tr_b16 a[84:85], v24 offset:20480
    ds_read_b64_tr_b16 a[86:87], v24 offset:20992
    ds_read_b64_tr_b16 a[88:89], v24 offset:24576
    ds_read_b64_tr_b16 a[90:91], v24 offset:25088
    ds_read_b64_tr_b16 a[92:93], v24 offset:28672
    ds_read_b64_tr_b16 a[94:95], v24 offset:29184
    ds_read_b64_tr_b16 a[96:97], v24 offset:32768
    ds_read_b64_tr_b16 a[98:99], v24 offset:33280
    ds_read_b64_tr_b16 a[100:101], v24 offset:36864
    ds_read_b64_tr_b16 a[102:103], v24 offset:37376
    ds_read_b64_tr_b16 a[104:105], v24 offset:40960
    ds_read_b64_tr_b16 a[106:107], v24 offset:41472
    ds_read_b64_tr_b16 a[108:109], v24 offset:45056
    ds_read_b64_tr_b16 a[110:111], v24 offset:45568
    ds_read_b64_tr_b16 a[112:113], v24 offset:49152
    ds_read_b64_tr_b16 a[114:115], v24 offset:49664
    ds_read_b64_tr_b16 a[116:117], v24 offset:53248
    ds_read_b64_tr_b16 a[118:119], v24 offset:53760
    ds_read_b64_tr_b16 a[120:121], v24 offset:57344
    ds_read_b64_tr_b16 a[122:123], v24 offset:57856
    ds_read_b64_tr_b16 a[124:125], v24 offset:61440
    ds_read_b64_tr_b16 a[126:127], v24 offset:61952
    s_lshl_b32 s73, s3, 11
    s_add_u32 s74, s73, s79
    s_cmp_lg_u32 s3, 1
    s_cbranch_scc1 L_wskip_6
    s_lshl_b32 s88, s4, 6
    s_add_u32 s88, s88, 0x2000
    s_lshl_b32 s89, s5, 8
    s_add_u32 s89, s89, 0x5f00
    v_mov_b32 v109, s88
    v_mov_b32 v110, s89
    v_cmp_gt_u32 vcc, 32, v1
    v_lshlrev_b32 v108, 3, v1
    s_nop 0
    v_cndmask_b32 v109, v110, v109, vcc
    v_add_u32 v108, v108, v109
    s_mov_b32 s90, 0xffffff
    s_cmp_eq_u32 s4, 0
    s_cselect_b32 s90, 0xffff00, s90
    s_cmp_eq_u32 s4, 31
    s_cselect_b32 s90, 0xffff, s90
    s_mov_b32 s91, -1
    s_mov_b64 exec, s[90:91]
    s_mov_b32 s89, 0
L_wloop_7:
    buffer_load_dwordx2 v[110:111], v108, s[40:43], 0 offen sc1
    s_waitcnt vmcnt(0)
    v_cmp_eq_u32 vcc, s52, v110
    v_xor_b32 v111, s53, v111
    v_cmp_gt_u32 s[92:93], 16, v111
    s_nop 1
    s_and_b64 vcc, vcc, s[92:93]
    s_cmp_eq_u64 vcc, exec
    s_cbranch_scc1 L_wdone_8
    s_add_u32 s89, s89, 1
    s_cmp_lt_u32 s89, 0x8000
    s_cbranch_scc1 L_wloop_7
    s_or_b32 s80, s80, 2
L_wdone_8:
    s_getreg_b32 s88, hwreg(HW_REG_XCC_ID, 0, 4)
    v_cmp_eq_u32 vcc, s88, v111
    s_nop 1
    s_lshr_b32 s88, vcc_lo, 8
    s_and_b32 s88, s88, 0xff
    s_cmp_eq_u32 s88, 0xff
    s_cselect_b32 s88, 1, 0
    s_cmp_eq_u32 s80, 0
    s_cselect_b32 s88, s88, 0
    s_mov_b64 exec, 1
    v_mov_b32 v110, s88
    v_mov_b32 v108, 162816
    ds_write_b32 v108, v110
    s_waitcnt lgkmcnt(0)
    s_mov_b64 exec, -1
L_wskip_6:
    s_barrier
    v_mov_b32 v108, 162816
    ds_read_b32 v109, v108
    s_waitcnt lgkmcnt(0)
    v_readfirstlane_b32 s96, v109
    s_add_u32 m0, s73, 0
    s_add_u32 s95, s74, 1048576
    buffer_load_dwordx4 v4, s[40:43], s95 offen sc1 lds
    buffer_load_dwordx4 v4, s[40:43], s95 offen offset:1024 sc1 lds
    s_add_u32 m0, s73, 16384
    s_add_u32 s95, s74, 1064960
    buffer_load_dwordx4 v4, s[40:43], s95 offen sc1 lds
    buffer_load_dwordx4 v4, s[40:43], s95 offen offset:1024 sc1 lds
    s_add_u32 m0, s73, 32768
    s_add_u32 s95, s74, 1081344
    buffer_load_dwordx4 v4, s[40:43], s95 offen sc1 lds
    buffer_load_dwordx4 v4, s[40:43], s95 offen offset:1024 sc1 lds
    s_add_u32 m0, s73, 49152
    s_add_u32 s95, s74, 1097728
    buffer_load_dwordx4 v4, s[40:43], s95 offen sc1 lds
    buffer_load_dwordx4 v4, s[40:43], s95 offen offset:1024 sc1 lds
    s_lshl_b32 s88, s6, 11
    v_add_u32 v52, s88, v4
    v_lshlrev_b32 v56, 16, v12
    v_and_b32 v57, 0xffff0000, v12
    v_lshlrev_b32 v58, 16, v13
    v_and_b32 v59, 0xffff0000, v13
    v_lshlrev_b32 v60, 16, v14
    v_and_b32 v61, 0xffff0000, v14
    v_lshlrev_b32 v62, 16, v15
    v_and_b32 v63, 0xffff0000, v15
    s_lshl_b32 s89, s5, 1
    s_lshr_b32 s90, s7, 1
    s_add_u32 s89, s89, s90
    s_lshl_b32 s89, s89, 12
    s_add_u32 s75, s79, s89
    s_and_b32 s89, s7, 1
    s_lshl_b32 s89, s89, 9
    s_add_u32 s75, s75, s89
    s_lshl_b32 s89, s6, 11
    s_add_u32 s75, s75, s89
    s_add_u32 s75, s75, 0x300000
    s_lshl_b32 s88, s7, 9
    s_lshl_b32 s89, s6, 8
    s_add_u32 s88, s88, s89
    s_add_u32 s88, s88, 16384
    v_lshlrev_b32 v53, 3, v1
    v_add_u32 v54, s88, v53
    s_waitcnt vmcnt(6)
    s_barrier
    s_cmp_lg_u32 s3, 0
    s_cbranch_scc1 L_sig_9
    s_lshl_b32 s88, s5, 8
    s_lshl_b32 s89, s4, 3
    s_add_u32 s88, s88, s89
    s_add_u32 s88, s88, 0x1000
    v_mov_b32 v108, s52
    v_mov_b32 v109, s53
    v_mov_b32 v110, s88
    s_mov_b64 exec, 1
    buffer_store_dwordx2 v[108:109], v110, s[40:43], 0 offen sc0 sc1
    s_mov_b64 exec, -1
L_sig_9:
    ds_read_b128 v[36:39], v52 offset:0
    ds_read_b128 v[40:43], v52 offset:1024
    ds_read_b128 v[44:47], v52 offset:4096
    ds_read_b128 v[48:51], v52 offset:5120
    s_waitcnt lgkmcnt(2)
    v_mfma_f32_16x16x32_bf16 v[28:31], a[64:67], v[36:39], 0
    v_mfma_f32_16x16x32_bf16 v[32:35], a[64:67], v[40:43], 0
    ds_read_b128 v[36:39], v52 offset:8192
    ds_read_b128 v[40:43], v52 offset:9216
    s_waitcnt lgkmcnt(2)
    v_mfma_f32_16x16x32_bf16 v[28:31], a[68:71], v[44:47], v[28:31]
    v_mfma_f32_16x16x32_bf16 v[32:35], a[68:71], v[48:51], v[32:35]
    s_add_u32 s95, s97, 0
    s_and_b32 s95, s95, 0x3fff
    s_add_u32 s95, s95, s72
    buffer_load_dwordx4 a[0:3], v4, s[40:43], s95 offen offset:0 sc1
    ds_read_b128 v[44:47], v52 offset:12288
    ds_read_b128 v[48:51], v52 offset:13312
    s_waitcnt lgkmcnt(2)
    v_mfma_f32_16x16x32_bf16 v[28:31], a[72:75], v[36:39], v[28:31]
    v_mfma_f32_16x16x32_bf16 v[32:35], a[72:75], v[40:43], v[32:35]
    s_waitcnt vmcnt(5)
    s_barrier
    ds_read_b128 v[36:39], v52 offset:16384
    ds_read_b128 v[40:43], v52 offset:17408
    s_waitcnt lgkmcnt(2)
    v_mfma_f32_16x16x32_bf16 v[28:31], a[76:79], v[44:47], v[28:31]
    v_mfma_f32_16x16x32_bf16 v[32:35], a[76:79], v[48:51], v[32:35]
    s_add_u32 s95, s97, 0
    s_and_b32 s95, s95, 0x3fff
    s_add_u32 s95, s95, s81
    buffer_load_dwordx4 a[4:7], v4, s[40:43], s95 offen offset:0 sc1
    ds_read_b128 v[44:47], v52 offset:20480
    ds_read_b128 v[48:51], v52 offset:21504
    s_waitcnt lgkmcnt(2)
    v_mfma_f32_16x16x32_bf16 v[28:31], a[80:83], v[36:39], v[28:31]
    v_mfma_f32_16x16x32_bf16 v[32:35], a[80:83], v[40:43], v[32:35]
    ds_read_b128 v[36:39], v52 offset:24576
    ds_read_b128 v[40:43], v52 offset:25600
    s_waitcnt lgkmcnt(2)
    v_mfma_f32_16x16x32_bf16 v[28:31], a[84:87], v[44:47], v[28:31]
    v_mfma_f32_16x16x32_bf16 v[32:35], a[84:87], v[48:51], v[32:35]
    s_add_u32 s95, s97, 0
    s_and_b32 s95, s95, 0x3fff
    s_add_u32 s95, s95, s72
    buffer_load_dwordx4 a[8:11], v4, s[40:43], s95 offen offset:1024 sc1
    ds_read_b128 v[44:47], v52 offset:28672
    ds_read_b128 v[48:51], v52 offset:29696
    s_waitcnt lgkmcnt(2)
    v_mfma_f32_16x16x32_bf16 v[28:31], a[88:91], v[36:39], v[28:31]
    v_mfma_f32_16x16x32_bf16 v[32:35], a[88:91], v[40:43], v[32:35]
    s_waitcnt vmcnt(5)
    s_barrier
    ds_read_b128 v[36:39], v52 offset:32768
    ds_read_b128 v[40:43], v52 offset:33792
    s_waitcnt lgkmcnt(2)
    v_mfma_f32_16x16x32_bf16 v[28:31], a[92:95], v[44:47], v[28:31]
    v_mfma_f32_16x16x32_bf16 v[32:35], a[92:95], v[48:51], v[32:35]
    s_add_u32 s95, s97, 0
    s_and_b32 s95, s95, 0x3fff
    s_add_u32 s95, s95, s81
    buffer_load_dwordx4 a[12:15], v4, s[40:43], s95 offen offset:1024 sc1
    ds_read_b128 v[44:47], v52 offset:36864
    ds_read_b128 v[48:51], v52 offset:37888
    s_waitcnt lgkmcnt(2)
    v_mfma_f32_16x16x32_bf16 v[28:31], a[96:99], v[36:39], v[28:31]
    v_mfma_f32_16x16x32_bf16 v[32:35], a[96:99], v[40:43], v[32:35]
    ds_read_b128 v[36:39], v52 offset:40960
    ds_read_b128 v[40:43], v52 offset:41984
    s_waitcnt lgkmcnt(2)
    v_mfma_f32_16x16x32_bf16 v[28:31], a[100:103], v[44:47], v[28:31]
    v_mfma_f32_16x16x32_bf16 v[32:35], a[100:103], v[48:51], v[32:35]
    s_add_u32 s95, s97, 0
    s_and_b32 s95, s95, 0x3fff
    s_add_u32 s95, s95, s72
    buffer_load_dwordx4 a[16:19], v4, s[40:43], s95 offen offset:2048 sc1
    ds_read_b128 v[44:47], v52 offset:45056
    ds_read_b128 v[48:51], v52 offset:46080
    s_waitcnt lgkmcnt(2)
    v_mfma_f32_16x16x32_bf16 v[28:31], a[104:107], v[36:39], v[28:31]
    v_mfma_f32_16x16x32_bf16 v[32:35], a[104:107], v[40:43], v[32:35]
    s_waitcnt vmcnt(5)
    s_barrier
    ds_read_b128 v[36:39], v52 offset:49152
    ds_read_b128 v[40:43], v52 offset:50176
    s_waitcnt lgkmcnt(2)
    v_mfma_f32_16x16x32_bf16 v[28:31], a[108:111], v[44:47], v[28:31]
    v_mfma_f32_16x16x32_bf16 v[32:35], a[108:111], v[48:51], v[32:35]
    s_add_u32 s95, s97, 0
    s_and_b32 s95, s95, 0x3fff
    s_add_u32 s95, s95, s81
    buffer_load_dwordx4 a[20:23], v4, s[40:43], s95 offen offset:2048 sc1
    ds_read_b128 v[44:47], v52 offset:53248
    ds_read_b128 v[48:51], v52 offset:54272
    s_waitcnt lgkmcnt(2)
    v_mfma_f32_16x16x32_bf16 v[28:31], a[112:115], v[36:39], v[28:31]
    v_mfma_f32_16x16x32_bf16 v[32:35], a[112:115], v[40:43], v[32:35]
    ds_read_b128 v[36:39], v52 offset:57344
    ds_read_b128 v[40:43], v52 offset:58368
    s_waitcnt lgkmcnt(2)
    v_mfma_f32_16x16x32_bf16 v[28:31], a[116:119], v[44:47], v[28:31]
    v_mfma_f32_16x16x32_bf16 v[32:35], a[116:119], v[48:51], v[32:35]
    s_add_u32 s95, s97, 0
    s_and_b32 s95, s95, 0x3fff
    s_add_u32 s95, s95, s72
    buffer_load_dwordx4 a[24:27], v4, s[40:43], s95 offen offset:3072 sc1
    ds_read_b128 v[44:47], v52 offset:61440
    ds_read_b128 v[48:51], v52 offset:62464
    s_waitcnt lgkmcnt(2)
    v_mfma_f32_16x16x32_bf16 v[28:31], a[120:123], v[36:39], v[28:31]
    v_mfma_f32_16x16x32_bf16 v[32:35], a[120:123], v[40:43], v[32:35]
    s_waitcnt lgkmcnt(0)
    v_mfma_f32_16x16x32_bf16 v[28:31], a[124:127], v[44:47], v[28:31]
    v_mfma_f32_16x16x32_bf16 v[32:35], a[124:127], v[48:51], v[32:35]
    s_add_u32 s95, s97, 0
    s_and_b32 s95, s95, 0x3fff
    s_add_u32 s95, s95, s81
    buffer_load_dwordx4 a[28:31], v4, s[40:43], s95 offen offset:3072 sc1
    s_nop 2
    v_pk_add_f32 v[28:29], v[28:29], v[56:57]
    v_pk_add_f32 v[30:31], v[30:31], v[58:59]
    v_pk_add_f32 v[32:33], v[32:33], v[60:61]
    v_pk_add_f32 v[34:35], v[34:35], v[62:63]
    v_cvt_pk_bf16_f32 v16, v28, v29
    v_cvt_pk_bf16_f32 v17, v30, v31
    v_cvt_pk_bf16_f32 v18, v32, v33
    v_cvt_pk_bf16_f32 v19, v34, v35
    v_mov_b32 v64, v16
    v_mov_b32 v65, v17
    v_mov_b32 v66, v18
    v_mov_b32 v67, v19
    v_mov_b32 v68, 0
    v_mov_b32 v69, 0
    v_mov_b32 v70, 0
    v_mov_b32 v71, 0
    v_permlane32_swap_b32 v64, v66
    v_permlane32_swap_b32 v65, v67
    s_nop 0
    v_permlane16_swap_b32 v64, v66
    v_permlane16_swap_b32 v65, v67
    s_cmp_eq_u32 s96, 0
    s_cbranch_scc1 L_slow_10
    buffer_store_dwordx4 v[64:67], v7, s[40:43], s75 offen
    s_branch L_stdone_11
L_slow_10:
    buffer_store_dwordx4 v[64:67], v7, s[40:43], s75 offen sc0 sc1
L_stdone_11:
    v_dot2_f32_bf16 v68, v16, v20, v68
    v_dot2_f32_bf16 v69, v16, v16, v69
    v_dot2_f32_bf16 v70, v18, v20, v70
    v_dot2_f32_bf16 v71, v18, v18, v71
    v_dot2_f32_bf16 v68, v17, v20, v68
    v_dot2_f32_bf16 v69, v17, v17, v69
    v_dot2_f32_bf16 v70, v19, v20, v70
    v_dot2_f32_bf16 v71, v19, v19, v71
    v_mov_b32 v72, v68
    v_mov_b32 v73, v69
    v_mov_b32 v74, v70
    v_mov_b32 v75, v71
    v_permlane32_swap_b32 v68, v72
    v_permlane32_swap_b32 v69, v73
    v_permlane32_swap_b32 v70, v74
    v_permlane32_swap_b32 v71, v75
    v_add_f32 v68, v68, v72
    v_add_f32 v69, v69, v73
    v_add_f32 v70, v70, v74
    v_add_f32 v71, v71, v75
    v_mov_b32 v72, v68
    v_mov_b32 v73, v69
    v_mov_b32 v74, v70
    v_mov_b32 v75, v71
    v_permlane16_swap_b32 v68, v72
    v_permlane16_swap_b32 v69, v73
    v_permlane16_swap_b32 v70, v74
    v_permlane16_swap_b32 v71, v75
    v_add_f32 v68, v68, v72
    v_add_f32 v69, v69, v73
    v_add_f32 v70, v70, v74
    v_add_f32 v71, v71, v75
    v_cmp_eq_u32 vcc, 1, v3
    s_nop 1
    v_cndmask_b32 v68, v68, v70, vcc
    v_cndmask_b32 v69, v69, v71, vcc
    s_mov_b32 exec_hi, 0
    ds_write_b64 v54, v[68:69]
    s_mov_b64 exec, -1
    s_waitcnt lgkmcnt(0)
    s_barrier
    s_cmp_lg_u32 s3, 0
    s_cbranch_scc1 L_st2_12
    ds_read_b64 v[68:69], v53 offset:16384
    ds_read_b64 v[70:71], v53 offset:16896
    ds_read_b64 v[72:73], v53 offset:17408
    ds_read_b64 v[74:75], v53 offset:17920
    s_lshl_b32 s88, s4, 12
    s_lshl_b32 s89, s5, 9
    s_add_u32 s88, s88, s89
    s_add_u32 s88, s88, 0x500000
    s_waitcnt lgkmcnt(0)
    v_pk_add_f32 v[68:69], v[68:69], v[70:71]
    v_pk_add_f32 v[72:73], v[72:73], v[74:75]
    v_pk_add_f32 v[68:69], v[68:69], v[72:73]
    s_cmp_eq_u32 s96, 0
    s_cbranch_scc1 L_slow_13
    buffer_store_dwordx2 v[68:69], v53, s[40:43], s88 offen
    s_branch L_stdone_14
L_slow_13:
    buffer_store_dwordx2 v[68:69], v53, s[40:43], s88 offen sc0 sc1
L_stdone_14:
L_st2_12:
    s_add_u32 s95, s97, 4096
    s_and_b32 s95, s95, 0x3fff
    s_add_u32 s95, s95, s72
    buffer_load_dwordx4 a[32:35], v4, s[40:43], s95 offen offset:0 sc1
    s_add_u32 s95, s97, 4096
    s_and_b32 s95, s95, 0x3fff
    s_add_u32 s95, s95, s81
    buffer_load_dwordx4 a[36:39], v4, s[40:43], s95 offen offset:0 sc1
    s_add_u32 s95, s97, 4096
    s_and_b32 s95, s95, 0x3fff
    s_add_u32 s95, s95, s72
    buffer_load_dwordx4 a[40:43], v4, s[40:43], s95 offen offset:1024 sc1
    s_add_u32 s95, s97, 4096
    s_and_b32 s95, s95, 0x3fff
    s_add_u32 s95, s95, s81
    buffer_load_dwordx4 a[44:47], v4, s[40:43], s95 offen offset:1024 sc1
    s_waitcnt vmcnt(4)
    s_barrier
    s_cmp_lg_u32 s3, 0
    s_cbranch_scc1 L_sig_15
    s_add_u32 s88, s4, 0
    s_lshl_b32 s88, s88, 7
    s_lshl_b32 s89, s5, 3
    s_add_u32 s88, s88, s89
    s_add_u32 s88, s88, 0x3000
    v_mov_b32 v108, s52
    v_mov_b32 v109, s53
    v_mov_b32 v110, s88
    s_mov_b64 exec, 1
    s_cmp_eq_u32 s96, 0
    s_cbranch_scc1 L_slow_16
    buffer_store_dwordx2 v[108:109], v110, s[40:43], 0 offen
    s_branch L_stdone_17
L_slow_16:
    buffer_store_dwordx2 v[108:109], v110, s[40:43], 0 offen sc0 sc1
L_stdone_17:
    s_mov_b64 exec, -1
L_sig_15:
    s_add_u32 s95, s97, 4096
    s_and_b32 s95, s95, 0x3fff
    s_add_u32 s95, s95, s72
    buffer_load_dwordx4 a[48:51], v4, s[40:43], s95 offen offset:2048 sc1
    s_add_u32 s95, s97, 4096
    s_and_b32 s95, s95, 0x3fff
    s_add_u32 s95, s95, s81
    buffer_load_dwordx4 a[52:55], v4, s[40:43], s95 offen offset:2048 sc1
    s_add_u32 s95, s97, 4096
    s_and_b32 s95, s95, 0x3fff
    s_add_u32 s95, s95, s72
    buffer_load_dwordx4 a[56:59], v4, s[40:43], s95 offen offset:3072 sc1
    s_add_u32 s95, s97, 4096
    s_and_b32 s95, s95, 0x3fff
    s_add_u32 s95, s95, s81
    buffer_load_dwordx4 a[60:63], v4, s[40:43], s95 offen offset:3072 sc1
    s_add_u32 s95, s97, 8192
    s_and_b32 s95, s95, 0x3fff
    s_add_u32 s95, s95, s72
    buffer_load_dwordx4 a[64:67], v4, s[40:43], s95 offen offset:0 sc1
    s_add_u32 s95, s97, 8192
    s_and_b32 s95, s95, 0x3fff
    s_add_u32 s95, s95, s81
    buffer_load_dwordx4 a[68:71], v4, s[40:43], s95 offen offset:0 sc1
    s_add_u32 s95, s97, 8192
    s_and_b32 s95, s95, 0x3fff
    s_add_u32 s95, s95, s72
    buffer_load_dwordx4 a[72:75], v4, s[40:43], s95 offen offset:1024 sc1
    s_add_u32 s95, s97, 8192
    s_and_b32 s95, s95, 0x3fff
    s_add_u32 s95, s95, s81
    buffer_load_dwordx4 a[76:79], v4, s[40:43], s95 offen offset:1024 sc1
    s_add_u32 s95, s97, 8192
    s_and_b32 s95, s95, 0x3fff
    s_add_u32 s95, s95, s72
    buffer_load_dwordx4 a[80:83], v4, s[40:43], s95 offen offset:2048 sc1
    s_add_u32 s95, s97, 8192
    s_and_b32 s95, s95, 0x3fff
    s_add_u32 s95, s95, s81
    buffer_load_dwordx4 a[84:87], v4, s[40:43], s95 offen offset:2048 sc1
    s_add_u32 s95, s97, 8192
    s_and_b32 s95, s95, 0x3fff
    s_add_u32 s95, s95, s72
    buffer_load_dwordx4 a[88:91], v4, s[40:43], s95 offen offset:3072 sc1
    s_add_u32 s95, s97, 8192
    s_and_b32 s95, s95, 0x3fff
    s_add_u32 s95, s95, s81
    buffer_load_dwordx4 a[92:95], v4, s[40:43], s95 offen offset:3072 sc1
    s_lshl_b32 s73, s3, 11
    s_add_u32 s74, s73, s79
    s_xor_b32 s88, s7, 1
    s_sub_u32 s88, s88, s7
    s_mul_i32 s88, s88, 57344
    s_add_u32 s83, s82, s88
    s_and_b32 s88, s4, 3
    s_lshl_b32 s88, s88, 1
    s_add_u32 s88, s88, s5
    s_sub_u32 s89, s88, 7
    s_cmp_ge_u32 s88, 7
    s_cselect_b32 s88, s89, s88
    s_sub_u32 s89, s88, 7
    s_cmp_ge_u32 s88, 7
    s_cselect_b32 s88, s89, s88
    s_lshl_b32 s68, s88, 11
    s_add_u32 s88, s88, 1
    s_cmp_eq_u32 s88, 7
    s_cselect_b32 s88, 0, s88
    s_lshl_b32 s69, s88, 11
    s_add_u32 s88, s88, 1
    s_cmp_eq_u32 s88, 7
    s_cselect_b32 s88, 0, s88
    s_lshl_b32 s70, s88, 11
    s_add_u32 s88, s88, 1
    s_cmp_eq_u32 s88, 7
    s_cselect_b32 s88, 0, s88
    s_lshl_b32 s71, s88, 11
    s_add_u32 s88, s88, 1
    s_cmp_eq_u32 s88, 7
    s_cselect_b32 s88, 0, s88
    s_lshl_b32 s99, s88, 11
    s_add_u32 s88, s88, 1
    s_cmp_eq_u32 s88, 7
    s_cselect_b32 s88, 0, s88
    s_lshl_b32 s100, s88, 11
    s_add_u32 s88, s88, 1
    s_cmp_eq_u32 s88, 7
    s_cselect_b32 s88, 0, s88
    s_lshl_b32 s101, s88, 11
    s_cmp_lg_u32 s3, 1
    s_cbranch_scc1 L_wskip_18
    s_lshl_b32 s88, s4, 7
    s_add_u32 s88, s88, 0x3000
    s_lshl_b32 s89, s5, 8
    s_add_u32 s89, s89, 0xf00
    v_mov_b32 v109, s88
    v_mov_b32 v110, s89
    v_cmp_gt_u32 vcc, 32, v1
    v_lshlrev_b32 v108, 3, v1
    s_nop 0
    v_cndmask_b32 v109, v110, v109, vcc
    v_add_u32 v108, v108, v109
    s_mov_b32 s90, 0xff
    s_mov_b32 s91, -1
    s_mov_b64 exec, s[90:91]
    s_mov_b32 s89, 0
L_wloop_19:
    buffer_load_dwordx2 v[110:111], v108, s[40:43], 0 offen sc1
    s_waitcnt vmcnt(0)
    v_cmp_eq_u32 vcc, s52, v110
    v_cmp_eq_u32 s[92:93], s53, v111
    s_nop 1
    s_and_b64 vcc, vcc, s[92:93]
    s_cmp_eq_u64 vcc, exec
    s_cbranch_scc1 L_wdone_20
    s_add_u32 s89, s89, 1
    s_cmp_lt_u32 s89, 0x8000
    s_cbranch_scc1 L_wloop_19
    s_or_b32 s80, s80, 4
L_wdone_20:
    s_mov_b64 exec, -1
L_wskip_18:
    s_barrier
    s_lshl_b32 s94, s97, 2
    s_add_u32 s94, s94, 0
    s_and_b32 s94, s94, 0xffff
    s_add_u32 s94, s94, s74
    s_add_u32 m0, s73, 0
    s_add_u32 s95, s94, 3145728
    buffer_load_dwordx4 v4, s[40:43], s95 offen sc1 lds
    buffer_load_dwordx4 v4, s[40:43], s95 offen offset:1024 sc1 lds
    s_lshl_b32 s94, s97, 2
    s_add_u32 s94, s94, 16384
    s_and_b32 s94, s94, 0xffff
    s_add_u32 s94, s94, s74
    s_add_u32 m0, s73, 16384
    s_add_u32 s95, s94, 3145728
    buffer_load_dwordx4 v4, s[40:43], s95 offen sc1 lds
    buffer_load_dwordx4 v4, s[40:43], s95 offen offset:1024 sc1 lds
    s_and_b32 s88, s7, 1
    s_mul_i32 s88, s88, s6
    s_lshl_b32 s76, s88, 11
    v_add_u32 v112, s76, v4
    s_sub_u32 s77, 0x800, s76
    v_add_u32 v113, s77, v4
    s_mul_i32 s75, s4, 229376
    s_mul_i32 s93, s5, 28672
    s_add_u32 s75, s75, s93
    s_add_u32 s75, s75, 0xa00000
    s_lshl_b32 s78, s4, 12
    s_add_u32 s78, s78, s54
    s_mul_i32 s87, s6, 16640
    s_add_u32 s87, s87, 121344
    s_lshl_b32 s88, s5, 6
    s_lshl_b32 s89, s4, 1
    s_add_u32 s88, s88, s89
    s_add_u32 s88, s88, s6
    s_lshl_b32 s86, s88, 12
    s_mul_i32 s85, s6, 4608
    s_add_u32 s85, s85, 154624
    s_cmp_ge_u32 s3, 4
    s_cbranch_scc1 L_g3B_21
    s_waitcnt vmcnt(2)
    s_barrier
    ds_read_b128 v[60:63], v112 offset:0
    ds_read_b128 v[64:67], v112 offset:1024
    ds_read_b128 v[68:71], v113 offset:0
    ds_read_b128 v[72:75], v113 offset:1024
    s_waitcnt lgkmcnt(3)
    v_mfma_f32_16x16x32_bf16 v[28:31], a[0:3], v[60:63], 0
    ds_read_b128 v[76:79], v112 offset:4096
    v_mfma_f32_16x16x32_bf16 v[32:35], a[4:7], v[60:63], 0
    ds_read_b128 v[80:83], v112 offset:5120
    s_waitcnt lgkmcnt(4)
    v_mfma_f32_16x16x32_bf16 v[36:39], a[0:3], v[64:67], 0
    ds_read_b128 v[84:87], v113 offset:4096
    v_mfma_f32_16x16x32_bf16 v[40:43], a[4:7], v[64:67], 0
    ds_read_b128 v[88:91], v113 offset:5120
    s_waitcnt lgkmcnt(5)
    v_mfma_f32_16x16x32_bf16 v[44:47], a[0:3], v[68:71], 0
    s_lshl_b32 s94, s97, 2
    s_add_u32 s94, s94, 32768
    s_and_b32 s94, s94, 0xffff
    s_add_u32 s94, s94, s74
    s_add_u32 m0, s73, 32768
    s_add_u32 s95, s94, 3145728
    buffer_load_dwordx4 v4, s[40:43], s95 offen sc1 lds
    buffer_load_dwordx4 v4, s[40:43], s95 offen offset:1024 sc1 lds
    v_mfma_f32_16x16x32_bf16 v[48:51], a[4:7], v[68:71], 0
    s_waitcnt lgkmcnt(4)
    v_mfma_f32_16x16x32_bf16 v[52:55], a[0:3], v[72:75], 0
    v_mfma_f32_16x16x32_bf16 v[56:59], a[4:7], v[72:75], 0
    s_waitcnt lgkmcnt(3)
    v_mfma_f32_16x16x32_bf16 v[28:31], a[8:11], v[76:79], v[28:31]
    ds_read_b128 v[60:63], v112 offset:8192
    v_mfma_f32_16x16x32_bf16 v[32:35], a[12:15], v[76:79], v[32:35]
    ds_read_b128 v[64:67], v112 offset:9216
    s_waitcnt lgkmcnt(4)
    v_mfma_f32_16x16x32_bf16 v[36:39], a[8:11], v[80:83], v[36:39]
    ds_read_b128 v[68:71], v113 offset:8192
    v_mfma_f32_16x16x32_bf16 v[40:43], a[12:15], v[80:83], v[40:43]
    ds_read_b128 v[72:75], v113 offset:9216
    s_waitcnt lgkmcnt(5)
    v_mfma_f32_16x16x32_bf16 v[44:47], a[8:11], v[84:87], v[44:47]
    s_add_u32 s95, s97, 12288
    s_and_b32 s95, s95, 0x3fff
    s_add_u32 s95, s95, s72
    buffer_load_dwordx4 a[96:99], v4, s[40:43], s95 offen offset:0 sc1
    s_add_u32 s95, s97, 12288
    s_and_b32 s95, s95, 0x3fff
    s_add_u32 s95, s95, s81
    buffer_load_dwordx4 a[100:103], v4, s[40:43], s95 offen offset:0 sc1
    v_mfma_f32_16x16x32_bf16 v[48:51], a[12:15], v[84:87], v[48:51]
    s_waitcnt lgkmcnt(4)
    v_mfma_f32_16x16x32_bf16 v[52:55], a[8:11], v[88:91], v[52:55]
    v_mfma_f32_16x16x32_bf16 v[56:59], a[12:15], v[88:91], v[56:59]
    s_waitcnt lgkmcnt(3)
    v_mfma_f32_16x16x32_bf16 v[28:31], a[16:19], v[60:63], v[28:31]
    ds_read_b128 v[76:79], v112 offset:12288
    v_mfma_f32_16x16x32_bf16 v[32:35], a[20:23], v[60:63], v[32:35]
    ds_read_b128 v[80:83], v112 offset:13312
    s_waitcnt lgkmcnt(4)
    v_mfma_f32_16x16x32_bf16 v[36:39], a[16:19], v[64:67], v[36:39]
    ds_read_b128 v[84:87], v113 offset:12288
    v_mfma_f32_16x16x32_bf16 v[40:43], a[20:23], v[64:67], v[40:43]
    ds_read_b128 v[88:91], v113 offset:13312
    s_waitcnt lgkmcnt(5)
    v_mfma_f32_16x16x32_bf16 v[44:47], a[16:19], v[68:71], v[44:47]
    s_lshl_b32 s94, s97, 2
    s_add_u32 s94, s94, 49152
    s_and_b32 s94, s94, 0xffff
    s_add_u32 s94, s94, s74
    s_add_u32 m0, s73, 49152
    s_add_u32 s95, s94, 3145728
    buffer_load_dwordx4 v4, s[40:43], s95 offen sc1 lds
    buffer_load_dwordx4 v4, s[40:43], s95 offen offset:1024 sc1 lds
    v_mfma_f32_16x16x32_bf16 v[48:51], a[20:23], v[68:71], v[48:51]
    s_waitcnt lgkmcnt(4)
    v_mfma_f32_16x16x32_bf16 v[52:55], a[16:19], v[72:75], v[52:55]
    v_mfma_f32_16x16x32_bf16 v[56:59], a[20:23], v[72:75], v[56:59]
    s_waitcnt vmcnt(6)
    s_barrier
    s_waitcnt lgkmcnt(3)
    v_mfma_f32_16x16x32_bf16 v[28:31], a[24:27], v[76:79], v[28:31]
    ds_read_b128 v[60:63], v112 offset:16384
    v_mfma_f32_16x16x32_bf16 v[32:35], a[28:31], v[76:79], v[32:35]
    ds_read_b128 v[64:67], v112 offset:17408
    s_waitcnt lgkmcnt(4)
    v_mfma_f32_16x16x32_bf16 v[36:39], a[24:27], v[80:83], v[36:39]
    ds_read_b128 v[68:71], v113 offset:16384
    v_mfma_f32_16x16x32_bf16 v[40:43], a[28:31], v[80:83], v[40:43]
    ds_read_b128 v[72:75], v113 offset:17408
    s_waitcnt lgkmcnt(5)
    v_mfma_f32_16x16x32_bf16 v[44:47], a[24:27], v[84:87], v[44:47]
    s_add_u32 s95, s97, 12288
    s_and_b32 s95, s95, 0x3fff
    s_add_u32 s95, s95, s72
    buffer_load_dwordx4 a[104:107], v4, s[40:43], s95 offen offset:1024 sc1
    s_add_u32 s95, s97, 12288
    s_and_b32 s95, s95, 0x3fff
    s_add_u32 s95, s95, s81
    buffer_load_dwordx4 a[108:111], v4, s[40:43], s95 offen offset:1024 sc1
    v_mfma_f32_16x16x32_bf16 v[48:51], a[28:31], v[84:87], v[48:51]
    s_waitcnt lgkmcnt(4)
    v_mfma_f32_16x16x32_bf16 v[52:55], a[24:27], v[88:91], v[52:55]
    v_mfma_f32_16x16x32_bf16 v[56:59], a[28:31], v[88:91], v[56:59]
    s_waitcnt lgkmcnt(3)
    v_mfma_f32_16x16x32_bf16 v[28:31], a[32:35], v[60:63], v[28:31]
    ds_read_b128 v[76:79], v112 offset:20480
    v_mfma_f32_16x16x32_bf16 v[32:35], a[36:39], v[60:63], v[32:35]
    ds_read_b128 v[80:83], v112 offset:21504
    s_waitcnt lgkmcnt(4)
    v_mfma_f32_16x16x32_bf16 v[36:39], a[32:35], v[64:67], v[36:39]
    ds_read_b128 v[84:87], v113 offset:20480
    v_mfma_f32_16x16x32_bf16 v[40:43], a[36:39], v[64:67], v[40:43]
    ds_read_b128 v[88:91], v113 offset:21504
    s_waitcnt lgkmcnt(5)
    v_mfma_f32_16x16x32_bf16 v[44:47], a[32:35], v[68:71], v[44:47]
    s_add_u32 s95, s97, 12288
    s_and_b32 s95, s95, 0x3fff
    s_add_u32 s95, s95, s72
    buffer_load_dwordx4 a[112:115], v4, s[40:43], s95 offen offset:2048 sc1
    s_add_u32 s95, s97, 12288
    s_and_b32 s95, s95, 0x3fff
    s_add_u32 s95, s95, s81
    buffer_load_dwordx4 a[116:119], v4, s[40:43], s95 offen offset:2048 sc1
    v_mfma_f32_16x16x32_bf16 v[48:51], a[36:39], v[68:71], v[48:51]
    s_waitcnt lgkmcnt(4)
    v_mfma_f32_16x16x32_bf16 v[52:55], a[32:35], v[72:75], v[52:55]
    v_mfma_f32_16x16x32_bf16 v[56:59], a[36:39], v[72:75], v[56:59]
    s_waitcnt lgkmcnt(3)
    v_mfma_f32_16x16x32_bf16 v[28:31], a[40:43], v[76:79], v[28:31]
    ds_read_b128 v[60:63], v112 offset:24576
    v_mfma_f32_16x16x32_bf16 v[32:35], a[44:47], v[76:79], v[32:35]
    ds_read_b128 v[64:67], v112 offset:25600
    s_waitcnt lgkmcnt(4)
    v_mfma_f32_16x16x32_bf16 v[36:39], a[40:43], v[80:83], v[36:39]
    ds_read_b128 v[68:71], v113 offset:24576
    v_mfma_f32_16x16x32_bf16 v[40:43], a[44:47], v[80:83], v[40:43]
    ds_read_b128 v[72:75], v113 offset:25600
    s_waitcnt lgkmcnt(5)
    v_mfma_f32_16x16x32_bf16 v[44:47], a[40:43], v[84:87], v[44:47]
    s_add_u32 s95, s97, 12288
    s_and_b32 s95, s95, 0x3fff
    s_add_u32 s95, s95, s72
    buffer_load_dwordx4 a[120:123], v4, s[40:43], s95 offen offset:3072 sc1
    s_add_u32 s95, s97, 12288
    s_and_b32 s95, s95, 0x3fff
    s_add_u32 s95, s95, s81
    buffer_load_dwordx4 a[124:127], v4, s[40:43], s95 offen offset:3072 sc1
    v_mfma_f32_16x16x32_bf16 v[48:51], a[44:47], v[84:87], v[48:51]
    s_waitcnt lgkmcnt(4)
    v_mfma_f32_16x16x32_bf16 v[52:55], a[40:43], v[88:91], v[52:55]
    v_mfma_f32_16x16x32_bf16 v[56:59], a[44:47], v[88:91], v[56:59]
    s_waitcnt lgkmcnt(3)
    v_mfma_f32_16x16x32_bf16 v[28:31], a[48:51], v[60:63], v[28:31]
    ds_read_b128 v[76:79], v112 offset:28672
    v_mfma_f32_16x16x32_bf16 v[32:35], a[52:55], v[60:63], v[32:35]
    ds_read_b128 v[80:83], v112 offset:29696
    s_waitcnt lgkmcnt(4)
    v_mfma_f32_16x16x32_bf16 v[36:39], a[48:51], v[64:67], v[36:39]
    ds_read_b128 v[84:87], v113 offset:28672
    v_mfma_f32_16x16x32_bf16 v[40:43], a[52:55], v[64:67], v[40:43]
    ds_read_b128 v[88:91], v113 offset:29696
    s_waitcnt lgkmcnt(5)
    v_mfma_f32_16x16x32_bf16 v[44:47], a[48:51], v[68:71], v[44:47]
    v_lshlrev_b32 v114, 6, v2
    v_lshl_add_u32 v114, v3, 4, v114
    v_mfma_f32_16x16x32_bf16 v[48:51], a[52:55], v[68:71], v[48:51]
    s_sub_u32 s95, s72, 0x1400000
    s_lshr_b32 s95, s95, 4
    s_add_u32 s95, s95, 0x520000
    buffer_load_dwordx4 v[120:123], v114, s[40:43], s95 offen sc1
    s_sub_u32 s95, s81, 0x1400000
    s_lshr_b32 s95, s95, 4
    s_add_u32 s95, s95, 0x520000
    buffer_load_dwordx4 v[124:127], v114, s[40:43], s95 offen sc1
    s_waitcnt lgkmcnt(4)
    v_mfma_f32_16x16x32_bf16 v[52:55], a[48:51], v[72:75], v[52:55]
    v_mfma_f32_16x16x32_bf16 v[56:59], a[52:55], v[72:75], v[56:59]
    s_waitcnt vmcnt(12)
    s_waitcnt lgkmcnt(0)
    s_barrier
    v_mfma_f32_16x16x32_bf16 v[28:31], a[56:59], v[76:79], v[28:31]
    ds_read_b128 v[60:63], v112 offset:32768
    v_mfma_f32_16x16x32_bf16 v[32:35], a[60:63], v[76:79], v[32:35]
    ds_read_b128 v[64:67], v112 offset:33792
    v_mfma_f32_16x16x32_bf16 v[36:39], a[56:59], v[80:83], v[36:39]
    ds_read_b128 v[68:71], v113 offset:32768
    v_mfma_f32_16x16x32_bf16 v[40:43], a[60:63], v[80:83], v[40:43]
    ds_read_b128 v[72:75], v113 offset:33792
    v_mfma_f32_16x16x32_bf16 v[44:47], a[56:59], v[84:87], v[44:47]
    s_add_u32 m0, s54, 0
    s_add_u32 s95, s78, 5242880
    buffer_load_dwordx4 v4, s[40:43], s95 offen sc1 lds
    v_mfma_f32_16x16x32_bf16 v[48:51], a[60:63], v[84:87], v[48:51]
    v_mfma_f32_16x16x32_bf16 v[52:55], a[56:59], v[88:91], v[52:55]
    v_mfma_f32_16x16x32_bf16 v[56:59], a[60:63], v[88:91], v[56:59]
    s_waitcnt lgkmcnt(3)
    v_mfma_f32_16x16x32_bf16 v[28:31], a[64:67], v[60:63], v[28:31]
    ds_read_b128 v[76:79], v112 offset:36864
    v_mfma_f32_16x16x32_bf16 v[32:35], a[68:71], v[60:63], v[32:35]
    ds_read_b128 v[80:83], v112 offset:37888
    s_waitcnt lgkmcnt(4)
    v_mfma_f32_16x16x32_bf16 v[36:39], a[64:67], v[64:67], v[36:39]
    ds_read_b128 v[84:87], v113 offset:36864
    v_mfma_f32_16x16x32_bf16 v[40:43], a[68:71], v[64:67], v[40:43]
    ds_read_b128 v[88:91], v113 offset:37888
    s_waitcnt lgkmcnt(5)
    v_mfma_f32_16x16x32_bf16 v[44:47], a[64:67], v[68:71], v[44:47]
    s_add_u32 s95, s82, s68
    buffer_load_dwordx4 a[0:3], v4, s[40:43], s95 offen offset:0 sc1
    v_mfma_f32_16x16x32_bf16 v[48:51], a[68:71], v[68:71], v[48:51]
    s_waitcnt lgkmcnt(4)
    v_mfma_f32_16x16x32_bf16 v[52:55], a[64:67], v[72:75], v[52:55]
    v_mfma_f32_16x16x32_bf16 v[56:59], a[68:71], v[72:75], v[56:59]
    s_waitcnt lgkmcnt(3)
    v_mfma_f32_16x16x32_bf16 v[28:31], a[72:75], v[76:79], v[28:31]
    ds_read_b128 v[60:63], v112 offset:40960
    v_mfma_f32_16x16x32_bf16 v[32:35], a[76:79], v[76:79], v[32:35]
    ds_read_b128 v[64:67], v112 offset:41984
    s_waitcnt lgkmcnt(4)
    v_mfma_f32_16x16x32_bf16 v[36:39], a[72:75], v[80:83], v[36:39]
    ds_read_b128 v[68:71], v113 offset:40960
    v_mfma_f32_16x16x32_bf16 v[40:43], a[76:79], v[80:83], v[40:43]
    ds_read_b128 v[72:75], v113 offset:41984
    s_waitcnt lgkmcnt(5)
    v_mfma_f32_16x16x32_bf16 v[44:47], a[72:75], v[84:87], v[44:47]
    s_add_u32 s95, s83, s68
    buffer_load_dwordx4 a[4:7], v4, s[40:43], s95 offen offset:0 sc1
    v_mfma_f32_16x16x32_bf16 v[48:51], a[76:79], v[84:87], v[48:51]
    s_waitcnt lgkmcnt(4)
    v_mfma_f32_16x16x32_bf16 v[52:55], a[72:75], v[88:91], v[52:55]
    v_mfma_f32_16x16x32_bf16 v[56:59], a[76:79], v[88:91], v[56:59]
    s_waitcnt lgkmcnt(3)
    v_mfma_f32_16x16x32_bf16 v[28:31], a[80:83], v[60:63], v[28:31]
    ds_read_b128 v[76:79], v112 offset:45056
    v_mfma_f32_16x16x32_bf16 v[32:35], a[84:87], v[60:63], v[32:35]
    ds_read_b128 v[80:83], v112 offset:46080
    s_waitcnt lgkmcnt(4)
    v_mfma_f32_16x16x32_bf16 v[36:39], a[80:83], v[64:67], v[36:39]
    ds_read_b128 v[84:87], v113 offset:45056
    v_mfma_f32_16x16x32_bf16 v[40:43], a[84:87], v[64:67], v[40:43]
    ds_read_b128 v[88:91], v113 offset:46080
    s_waitcnt lgkmcnt(5)
    v_mfma_f32_16x16x32_bf16 v[44:47], a[80:83], v[68:71], v[44:47]
    s_add_u32 s95, s82, s68
    buffer_load_dwordx4 a[8:11], v4, s[40:43], s95 offen offset:1024 sc1
    v_mfma_f32_16x16x32_bf16 v[48:51], a[84:87], v[68:71], v[48:51]
    s_waitcnt lgkmcnt(4)
    v_mfma_f32_16x16x32_bf16 v[52:55], a[80:83], v[72:75], v[52:55]
    v_mfma_f32_16x16x32_bf16 v[56:59], a[84:87], v[72:75], v[56:59]
    s_waitcnt vmcnt(3)
    s_waitcnt lgkmcnt(0)
    s_barrier
    v_mfma_f32_16x16x32_bf16 v[28:31], a[88:91], v[76:79], v[28:31]
    ds_read_b128 v[60:63], v112 offset:49152
    v_mfma_f32_16x16x32_bf16 v[32:35], a[92:95], v[76:79], v[32:35]
    ds_read_b128 v[64:67], v112 offset:50176
    v_mfma_f32_16x16x32_bf16 v[36:39], a[88:91], v[80:83], v[36:39]
    ds_read_b128 v[68:71], v113 offset:49152
    v_mfma_f32_16x16x32_bf16 v[40:43], a[92:95], v[80:83], v[40:43]
    ds_read_b128 v[72:75], v113 offset:50176
    v_mfma_f32_16x16x32_bf16 v[44:47], a[88:91], v[84:87], v[44:47]
    s_add_u32 s95, s83, s68
    buffer_load_dwordx4 a[12:15], v4, s[40:43], s95 offen offset:1024 sc1
    v_lshlrev_b32 v108, 3, v1
    v_mfma_f32_16x16x32_bf16 v[48:51], a[92:95], v[84:87], v[48:51]
    ds_read_b64 v[92:93], v108 offset:0
    ds_read_b64 v[94:95], v108 offset:512
    v_mfma_f32_16x16x32_bf16 v[52:55], a[88:91], v[88:91], v[52:55]
    ds_read_b64 v[96:97], v108 offset:1024
    ds_read_b64 v[98:99], v108 offset:1536
    v_mfma_f32_16x16x32_bf16 v[56:59], a[92:95], v[88:91], v[56:59]
    ds_read_b64 v[100:101], v108 offset:2048
    ds_read_b64 v[102:103], v108 offset:2560
    ds_read_b64 v[104:105], v108 offset:3072
    ds_read_b64 v[106:107], v108 offset:3584
    s_lshr_b32 s88, s76, 4
    v_lshlrev_b32 v114, 2, v2
    v_add_u32 v118, s88, v114
    s_lshr_b32 s88, s77, 4
    v_add_u32 v119, s88, v114
    s_waitcnt lgkmcnt(0)
    s_waitcnt vmcnt(7)
    v_mfma_f32_16x16x32_bf16 v[28:31], a[96:99], v[60:63], v[28:31]
    ds_read_b128 v[76:79], v112 offset:53248
    v_mfma_f32_16x16x32_bf16 v[32:35], a[100:103], v[60:63], v[32:35]
    ds_read_b128 v[80:83], v112 offset:54272
    v_mfma_f32_16x16x32_bf16 v[36:39], a[96:99], v[64:67], v[36:39]
    ds_read_b128 v[84:87], v113 offset:53248
    v_mfma_f32_16x16x32_bf16 v[40:43], a[100:103], v[64:67], v[40:43]
    ds_read_b128 v[88:91], v113 offset:54272
    v_mfma_f32_16x16x32_bf16 v[44:47], a[96:99], v[68:71], v[44:47]
    s_add_u32 s95, s82, s69
    buffer_load_dwordx4 a[16:19], v4, s[40:43], s95 offen offset:0 sc1
    s_waitcnt vmcnt(6)
    v_mfma_f32_16x16x32_bf16 v[48:51], a[100:103], v[68:71], v[48:51]
    v_add_f32_dpp v120, v120, v120 row_ror:1 row_mask:0xf bank_mask:0xf
    v_add_f32_dpp v121, v121, v121 row_ror:1 row_mask:0xf bank_mask:0xf
    v_mfma_f32_16x16x32_bf16 v[52:55], a[96:99], v[72:75], v[52:55]
    v_add_f32_dpp v122, v122, v122 row_ror:1 row_mask:0xf bank_mask:0xf
    v_add_f32_dpp v123, v123, v123 row_ror:1 row_mask:0xf bank_mask:0xf
    v_mfma_f32_16x16x32_bf16 v[56:59], a[100:103], v[72:75], v[56:59]
    v_add_f32_dpp v124, v124, v124 row_ror:1 row_mask:0xf bank_mask:0xf
    v_add_f32_dpp v125, v125, v125 row_ror:1 row_mask:0xf bank_mask:0xf
    v_add_f32_dpp v126, v126, v126 row_ror:1 row_mask:0xf bank_mask:0xf
    v_add_f32_dpp v127, v127, v127 row_ror:1 row_mask:0xf bank_mask:0xf
    v_add_f32 v92, v92, v94
    v_add_f32 v93, v93, v95
    v_add_f32 v96, v96, v98
    v_add_f32 v97, v97, v99
    v_add_f32 v100, v100, v102
    v_add_f32 v101, v101, v103
    v_add_f32 v104, v104, v106
    v_add_f32 v105, v105, v107
    v_add_f32 v92, v92, v96
    v_add_f32 v93, v93, v97
    v_add_f32 v100, v100, v104
    v_add_f32 v101, v101, v105
    v_add_f32 v92, v92, v100
    v_add_f32 v93, v93, v101
    v_mul_f32 v94, 0x3b000000, v92
    s_waitcnt lgkmcnt(3)
    v_mfma_f32_16x16x32_bf16 v[28:31], a[104:107], v[76:79], v[28:31]
    ds_read_b128 v[60:63], v112 offset:57344
    v_mfma_f32_16x16x32_bf16 v[32:35], a[108:111], v[76:79], v[32:35]
    ds_read_b128 v[64:67], v112 offset:58368
    s_waitcnt lgkmcnt(4)
    v_mfma_f32_16x16x32_bf16 v[36:39], a[104:107], v[80:83], v[36:39]
    ds_read_b128 v[68:71], v113 offset:57344
    v_mfma_f32_16x16x32_bf16 v[40:43], a[108:111], v[80:83], v[40:43]
    ds_read_b128 v[72:75], v113 offset:58368
    s_waitcnt lgkmcnt(5)
    v_mfma_f32_16x16x32_bf16 v[44:47], a[104:107], v[84:87], v[44:47]
    s_add_u32 s95, s83, s69
    buffer_load_dwordx4 a[20:23], v4, s[40:43], s95 offen offset:0 sc1
    v_add_f32_dpp v120, v120, v120 row_ror:2 row_mask:0xf bank_mask:0xf
    v_mfma_f32_16x16x32_bf16 v[48:51], a[108:111], v[84:87], v[48:51]
    v_add_f32_dpp v121, v121, v121 row_ror:2 row_mask:0xf bank_mask:0xf
    v_add_f32_dpp v122, v122, v122 row_ror:2 row_mask:0xf bank_mask:0xf
    s_waitcnt lgkmcnt(4)
    v_mfma_f32_16x16x32_bf16 v[52:55], a[104:107], v[88:91], v[52:55]
    v_add_f32_dpp v123, v123, v123 row_ror:2 row_mask:0xf bank_mask:0xf
    v_add_f32_dpp v124, v124, v124 row_ror:2 row_mask:0xf bank_mask:0xf
    v_mfma_f32_16x16x32_bf16 v[56:59], a[108:111], v[88:91], v[56:59]
    v_add_f32_dpp v125, v125, v125 row_ror:2 row_mask:0xf bank_mask:0xf
    v_add_f32_dpp v126, v126, v126 row_ror:2 row_mask:0xf bank_mask:0xf
    v_add_f32_dpp v127, v127, v127 row_ror:2 row_mask:0xf bank_mask:0xf
    v_add_f32_dpp v120, v120, v120 row_ror:4 row_mask:0xf bank_mask:0xf
    v_add_f32_dpp v121, v121, v121 row_ror:4 row_mask:0xf bank_mask:0xf
    v_add_f32_dpp v122, v122, v122 row_ror:4 row_mask:0xf bank_mask:0xf
    v_add_f32_dpp v123, v123, v123 row_ror:4 row_mask:0xf bank_mask:0xf
    v_mul_f32 v95, 0x3b000000, v93
    v_fma_f32 v95, -v94, v94, v95
    v_max_f32 v95, 0, v95
    v_add_f32 v95, 0x3727c5ac, v95
    v_rsq_f32 v96, v95
    v_sqrt_f32 v111, v95
    v_sub_f32 v108, 0, v94
    v_mul_f32 v109, 0xc0135761, v96
    v_mul_f32 v97, v96, v96
    v_mul_f32 v97, v97, v96
    v_mul_f32 v110, 0xbdd2d3e8, v97
    ds_bpermute_b32 v92, v118, v108 offset:0
    ds_bpermute_b32 v93, v118, v109 offset:0
    ds_bpermute_b32 v94, v118, v110 offset:0
    ds_bpermute_b32 v95, v118, v111 offset:0
    s_waitcnt lgkmcnt(7)
    v_mfma_f32_16x16x32_bf16 v[28:31], a[112:115], v[60:63], v[28:31]
    ds_read_b128 v[76:79], v112 offset:61440
    v_mfma_f32_16x16x32_bf16 v[32:35], a[116:119], v[60:63], v[32:35]
    ds_read_b128 v[80:83], v112 offset:62464
    s_waitcnt lgkmcnt(8)
    v_mfma_f32_16x16x32_bf16 v[36:39], a[112:115], v[64:67], v[36:39]
    ds_read_b128 v[84:87], v113 offset:61440
    v_mfma_f32_16x16x32_bf16 v[40:43], a[116:119], v[64:67], v[40:43]
    ds_read_b128 v[88:91], v113 offset:62464
    s_waitcnt lgkmcnt(9)
    v_mfma_f32_16x16x32_bf16 v[44:47], a[112:115], v[68:71], v[44:47]
    s_add_u32 s95, s82, s69
    buffer_load_dwordx4 a[24:27], v4, s[40:43], s95 offen offset:1024 sc1
    v_add_f32_dpp v124, v124, v124 row_ror:4 row_mask:0xf bank_mask:0xf
    v_mfma_f32_16x16x32_bf16 v[48:51], a[116:119], v[68:71], v[48:51]
    v_add_f32_dpp v125, v125, v125 row_ror:4 row_mask:0xf bank_mask:0xf
    v_add_f32_dpp v126, v126, v126 row_ror:4 row_mask:0xf bank_mask:0xf
    s_waitcnt lgkmcnt(8)
    v_mfma_f32_16x16x32_bf16 v[52:55], a[112:115], v[72:75], v[52:55]
    v_add_f32_dpp v127, v127, v127 row_ror:4 row_mask:0xf bank_mask:0xf
    v_add_f32_dpp v120, v120, v120 row_ror:8 row_mask:0xf bank_mask:0xf
    v_mfma_f32_16x16x32_bf16 v[56:59], a[116:119], v[72:75], v[56:59]
    v_add_f32_dpp v121, v121, v121 row_ror:8 row_mask:0xf bank_mask:0xf
    v_add_f32_dpp v122, v122, v122 row_ror:8 row_mask:0xf bank_mask:0xf
    v_add_f32_dpp v123, v123, v123 row_ror:8 row_mask:0xf bank_mask:0xf
    v_add_f32_dpp v124, v124, v124 row_ror:8 row_mask:0xf bank_mask:0xf
    v_add_f32_dpp v125, v125, v125 row_ror:8 row_mask:0xf bank_mask:0xf
    v_add_f32_dpp v126, v126, v126 row_ror:8 row_mask:0xf bank_mask:0xf
    v_add_f32_dpp v127, v127, v127 row_ror:8 row_mask:0xf bank_mask:0xf
    ds_bpermute_b32 v96, v118, v108 offset:64
    ds_bpermute_b32 v97, v118, v109 offset:64
    ds_bpermute_b32 v98, v118, v110 offset:64
    ds_bpermute_b32 v99, v118, v111 offset:64
    ds_bpermute_b32 v100, v119, v108 offset:0
    ds_bpermute_b32 v101, v119, v109 offset:0
    ds_bpermute_b32 v102, v119, v110 offset:0
    ds_bpermute_b32 v103, v119, v111 offset:0
    ds_bpermute_b32 v104, v119, v108 offset:64
    ds_bpermute_b32 v105, v119, v109 offset:64
    ds_bpermute_b32 v106, v119, v110 offset:64
    ds_bpermute_b32 v107, v119, v111 offset:64
    s_waitcnt lgkmcnt(15)
    v_mfma_f32_16x16x32_bf16 v[28:31], a[120:123], v[76:79], v[28:31]
    s_add_u32 s95, s83, s69
    buffer_load_dwordx4 a[28:31], v4, s[40:43], s95 offen offset:1024 sc1
    v_mfma_f32_16x16x32_bf16 v[32:35], a[124:127], v[76:79], v[32:35]
    s_waitcnt lgkmcnt(14)
    v_mfma_f32_16x16x32_bf16 v[36:39], a[120:123], v[80:83], v[36:39]
    v_mfma_f32_16x16x32_bf16 v[40:43], a[124:127], v[80:83], v[40:43]
    s_waitcnt lgkmcnt(13)
    v_mfma_f32_16x16x32_bf16 v[44:47], a[120:123], v[84:87], v[44:47]
    v_mfma_f32_16x16x32_bf16 v[48:51], a[124:127], v[84:87], v[48:51]
    s_waitcnt lgkmcnt(12)
    v_mfma_f32_16x16x32_bf16 v[52:55], a[120:123], v[88:91], v[52:55]
    v_mfma_f32_16x16x32_bf16 v[56:59], a[124:127], v[88:91], v[56:59]
    s_lshl_b32 s93, s7, 12
    s_add_u32 s73, s75, s93
    s_waitcnt lgkmcnt(0)
    v_fma_f32 v28, v120, v92, v28
    v_fma_f32 v29, v121, v92, v29
    v_fma_f32 v30, v122, v92, v30
    v_fma_f32 v31, v123, v92, v31
    v_fma_f32 v32, v124, v92, v32
    v_fma_f32 v33, v125, v92, v33
    v_fma_f32 v34, v126, v92, v34
    v_fma_f32 v35, v127, v92, v35
    v_pk_mul_f32 v[60:61], v[28:29], v[28:29]
    v_pk_mul_f32 v[62:63], v[30:31], v[30:31]
    v_pk_mul_f32 v[64:65], v[32:33], v[32:33]
    v_pk_mul_f32 v[66:67], v[34:35], v[34:35]
    v_fma_f32 v60, v60, v94, v93
    v_fma_f32 v61, v61, v94, v93
    v_fma_f32 v62, v62, v94, v93
    v_fma_f32 v63, v63, v94, v93
    v_fma_f32 v64, v64, v94, v93
    v_fma_f32 v65, v65, v94, v93
    v_fma_f32 v66, v66, v94, v93
    v_fma_f32 v67, v67, v94, v93
    v_pk_mul_f32 v[60:61], v[60:61], v[28:29]
    v_pk_mul_f32 v[62:63], v[62:63], v[30:31]
    v_pk_mul_f32 v[64:65], v[64:65], v[32:33]
    v_pk_mul_f32 v[66:67], v[66:67], v[34:35]
    v_exp_f32 v60, v60
    v_exp_f32 v61, v61
    v_exp_f32 v62, v62
    v_exp_f32 v63, v63
    v_exp_f32 v64, v64
    v_exp_f32 v65, v65
    v_exp_f32 v66, v66
    v_exp_f32 v67, v67
    v_fma_f32 v60, v60, v95, v95
    v_fma_f32 v61, v61, v95, v95
    v_fma_f32 v62, v62, v95, v95
    v_fma_f32 v63, v63, v95, v95
    v_fma_f32 v64, v64, v95, v95
    v_fma_f32 v65, v65, v95, v95
    v_fma_f32 v66, v66, v95, v95
    v_fma_f32 v67, v67, v95, v95
    v_rcp_f32 v60, v60
    v_rcp_f32 v61, v61
    v_rcp_f32 v62, v62
    v_rcp_f32 v63, v63
    v_rcp_f32 v64, v64
    v_rcp_f32 v65, v65
    v_rcp_f32 v66, v66
    v_rcp_f32 v67, v67
    v_pk_mul_f32 v[28:29], v[28:29], v[60:61]
    v_pk_mul_f32 v[30:31], v[30:31], v[62:63]
    v_pk_mul_f32 v[32:33], v[32:33], v[64:65]
    v_pk_mul_f32 v[34:35], v[34:35], v[66:67]
    v_cvt_pk_bf16_f32 v76, v28, v29
    v_cvt_pk_bf16_f32 v77, v30, v31
    v_cvt_pk_bf16_f32 v78, v32, v33
    v_cvt_pk_bf16_f32 v79, v34, v35
    s_nop 0
    v_permlane32_swap_b32 v76, v78
    v_permlane32_swap_b32 v77, v79
    s_nop 0
    v_permlane16_swap_b32 v76, v78
    v_permlane16_swap_b32 v77, v79
    s_cmp_eq_u32 s96, 0
    s_cbranch_scc1 L_slow_23
    buffer_store_dwordx4 v[76:79], v4, s[40:43], s73 offen offset:0
    s_branch L_stdone_24
L_slow_23:
    buffer_store_dwordx4 v[76:79], v4, s[40:43], s73 offen offset:0 sc0 sc1
L_stdone_24:
    s_lshl_b32 s89, s7, 10
    s_add_u32 s88, s86, s89
    s_add_u32 s89, s89, s85
    s_add_u32 m0, s89, 0
    s_add_u32 s95, s88, 6291456
    buffer_load_dwordx4 v4, s[40:43], s95 offen sc1 lds
    s_mul_i32 s90, s7, 4160
    s_add_u32 s90, s90, s87
    s_lshl_b32 s89, s7, 1
    s_add_u32 s89, s89, s86
    s_add_u32 m0, s90, 32
    s_nop 0
    buffer_load_dwordx4 v4, s[44:47], s89 offen  lds
    buffer_load_dwordx4 v4, s[44:47], s89 offen offset:1024  lds
    buffer_load_dwordx4 v4, s[44:47], s89 offen offset:2048  lds
    buffer_load_dwordx4 v4, s[44:47], s89 offen offset:3072  lds
    v_mov_b32 v25, s86
    buffer_load_dwordx2 v[26:27], v25, s[44:47], 0 offen
    v_fma_f32 v36, v120, v96, v36
    v_fma_f32 v37, v121, v96, v37
    v_fma_f32 v38, v122, v96, v38
    v_fma_f32 v39, v123, v96, v39
    v_fma_f32 v40, v124, v96, v40
    v_fma_f32 v41, v125, v96, v41
    v_fma_f32 v42, v126, v96, v42
    v_fma_f32 v43, v127, v96, v43
    v_pk_mul_f32 v[60:61], v[36:37], v[36:37]
    v_pk_mul_f32 v[62:63], v[38:39], v[38:39]
    v_pk_mul_f32 v[64:65], v[40:41], v[40:41]
    v_pk_mul_f32 v[66:67], v[42:43], v[42:43]
    v_fma_f32 v60, v60, v98, v97
    v_fma_f32 v61, v61, v98, v97
    v_fma_f32 v62, v62, v98, v97
    v_fma_f32 v63, v63, v98, v97
    v_fma_f32 v64, v64, v98, v97
    v_fma_f32 v65, v65, v98, v97
    v_fma_f32 v66, v66, v98, v97
    v_fma_f32 v67, v67, v98, v97
    v_pk_mul_f32 v[60:61], v[60:61], v[36:37]
    v_pk_mul_f32 v[62:63], v[62:63], v[38:39]
    v_pk_mul_f32 v[64:65], v[64:65], v[40:41]
    v_pk_mul_f32 v[66:67], v[66:67], v[42:43]
    v_exp_f32 v60, v60
    v_exp_f32 v61, v61
    v_exp_f32 v62, v62
    v_exp_f32 v63, v63
    v_exp_f32 v64, v64
    v_exp_f32 v65, v65
    v_exp_f32 v66, v66
    v_exp_f32 v67, v67
    v_fma_f32 v60, v60, v99, v99
    v_fma_f32 v61, v61, v99, v99
    v_fma_f32 v62, v62, v99, v99
    v_fma_f32 v63, v63, v99, v99
    v_fma_f32 v64, v64, v99, v99
    v_fma_f32 v65, v65, v99, v99
    v_fma_f32 v66, v66, v99, v99
    v_fma_f32 v67, v67, v99, v99
    v_rcp_f32 v60, v60
    v_rcp_f32 v61, v61
    v_rcp_f32 v62, v62
    v_rcp_f32 v63, v63
    v_rcp_f32 v64, v64
    v_rcp_f32 v65, v65
    v_rcp_f32 v66, v66
    v_rcp_f32 v67, v67
    v_pk_mul_f32 v[36:37], v[36:37], v[60:61]
    v_pk_mul_f32 v[38:39], v[38:39], v[62:63]
    v_pk_mul_f32 v[40:41], v[40:41], v[64:65]
    v_pk_mul_f32 v[42:43], v[42:43], v[66:67]
    v_cvt_pk_bf16_f32 v76, v36, v37
    v_cvt_pk_bf16_f32 v77, v38, v39
    v_cvt_pk_bf16_f32 v78, v40, v41
    v_cvt_pk_bf16_f32 v79, v42, v43
    s_nop 0
    v_permlane32_swap_b32 v76, v78
    v_permlane32_swap_b32 v77, v79
    s_nop 0
    v_permlane16_swap_b32 v76, v78
    v_permlane16_swap_b32 v77, v79
    s_cmp_eq_u32 s96, 0
    s_cbranch_scc1 L_slow_25
    buffer_store_dwordx4 v[76:79], v4, s[40:43], s73 offen offset:1024
    s_branch L_stdone_26
L_slow_25:
    buffer_store_dwordx4 v[76:79], v4, s[40:43], s73 offen offset:1024 sc0 sc1
L_stdone_26:
    v_fma_f32 v44, v120, v100, v44
    v_fma_f32 v45, v121, v100, v45
    v_fma_f32 v46, v122, v100, v46
    v_fma_f32 v47, v123, v100, v47
    v_fma_f32 v48, v124, v100, v48
    v_fma_f32 v49, v125, v100, v49
    v_fma_f32 v50, v126, v100, v50
    v_fma_f32 v51, v127, v100, v51
    v_pk_mul_f32 v[60:61], v[44:45], v[44:45]
    v_pk_mul_f32 v[62:63], v[46:47], v[46:47]
    v_pk_mul_f32 v[64:65], v[48:49], v[48:49]
    v_pk_mul_f32 v[66:67], v[50:51], v[50:51]
    v_fma_f32 v60, v60, v102, v101
    v_fma_f32 v61, v61, v102, v101
    v_fma_f32 v62, v62, v102, v101
    v_fma_f32 v63, v63, v102, v101
    v_fma_f32 v64, v64, v102, v101
    v_fma_f32 v65, v65, v102, v101
    v_fma_f32 v66, v66, v102, v101
    v_fma_f32 v67, v67, v102, v101
    v_pk_mul_f32 v[60:61], v[60:61], v[44:45]
    v_pk_mul_f32 v[62:63], v[62:63], v[46:47]
    v_pk_mul_f32 v[64:65], v[64:65], v[48:49]
    v_pk_mul_f32 v[66:67], v[66:67], v[50:51]
    v_exp_f32 v60, v60
    v_exp_f32 v61, v61
    v_exp_f32 v62, v62
    v_exp_f32 v63, v63
    v_exp_f32 v64, v64
    v_exp_f32 v65, v65
    v_exp_f32 v66, v66
    v_exp_f32 v67, v67
    v_fma_f32 v60, v60, v103, v103
    v_fma_f32 v61, v61, v103, v103
    v_fma_f32 v62, v62, v103, v103
    v_fma_f32 v63, v63, v103, v103
    v_fma_f32 v64, v64, v103, v103
    v_fma_f32 v65, v65, v103, v103
    v_fma_f32 v66, v66, v103, v103
    v_fma_f32 v67, v67, v103, v103
    v_rcp_f32 v60, v60
    v_rcp_f32 v61, v61
    v_rcp_f32 v62, v62
    v_rcp_f32 v63, v63
    v_rcp_f32 v64, v64
    v_rcp_f32 v65, v65
    v_rcp_f32 v66, v66
    v_rcp_f32 v67, v67
    v_pk_mul_f32 v[44:45], v[44:45], v[60:61]
    v_pk_mul_f32 v[46:47], v[46:47], v[62:63]
    v_pk_mul_f32 v[48:49], v[48:49], v[64:65]
    v_pk_mul_f32 v[50:51], v[50:51], v[66:67]
    v_cvt_pk_bf16_f32 v76, v44, v45
    v_cvt_pk_bf16_f32 v77, v46, v47
    v_cvt_pk_bf16_f32 v78, v48, v49
    v_cvt_pk_bf16_f32 v79, v50, v51
    s_nop 0
    v_permlane32_swap_b32 v76, v78
    v_permlane32_swap_b32 v77, v79
    s_nop 0
    v_permlane16_swap_b32 v76, v78
    v_permlane16_swap_b32 v77, v79
    s_cmp_eq_u32 s96, 0
    s_cbranch_scc1 L_slow_27
    buffer_store_dwordx4 v[76:79], v4, s[40:43], s73 offen offset:2048
    s_branch L_stdone_28
L_slow_27:
    buffer_store_dwordx4 v[76:79], v4, s[40:43], s73 offen offset:2048 sc0 sc1
L_stdone_28:
    v_fma_f32 v52, v120, v104, v52
    v_fma_f32 v53, v121, v104, v53
    v_fma_f32 v54, v122, v104, v54
    v_fma_f32 v55, v123, v104, v55
    v_fma_f32 v56, v124, v104, v56
    v_fma_f32 v57, v125, v104, v57
    v_fma_f32 v58, v126, v104, v58
    v_fma_f32 v59, v127, v104, v59
    v_pk_mul_f32 v[60:61], v[52:53], v[52:53]
    v_pk_mul_f32 v[62:63], v[54:55], v[54:55]
    v_pk_mul_f32 v[64:65], v[56:57], v[56:57]
    v_pk_mul_f32 v[66:67], v[58:59], v[58:59]
    v_fma_f32 v60, v60, v106, v105
    v_fma_f32 v61, v61, v106, v105
    v_fma_f32 v62, v62, v106, v105
    v_fma_f32 v63, v63, v106, v105
    v_fma_f32 v64, v64, v106, v105
    v_fma_f32 v65, v65, v106, v105
    v_fma_f32 v66, v66, v106, v105
    v_fma_f32 v67, v67, v106, v105
    v_pk_mul_f32 v[60:61], v[60:61], v[52:53]
    v_pk_mul_f32 v[62:63], v[62:63], v[54:55]
    v_pk_mul_f32 v[64:65], v[64:65], v[56:57]
    v_pk_mul_f32 v[66:67], v[66:67], v[58:59]
    v_exp_f32 v60, v60
    v_exp_f32 v61, v61
    v_exp_f32 v62, v62
    v_exp_f32 v63, v63
    v_exp_f32 v64, v64
    v_exp_f32 v65, v65
    v_exp_f32 v66, v66
    v_exp_f32 v67, v67
    v_fma_f32 v60, v60, v107, v107
    v_fma_f32 v61, v61, v107, v107
    v_fma_f32 v62, v62, v107, v107
    v_fma_f32 v63, v63, v107, v107
    v_fma_f32 v64, v64, v107, v107
    v_fma_f32 v65, v65, v107, v107
    v_fma_f32 v66, v66, v107, v107
    v_fma_f32 v67, v67, v107, v107
    v_rcp_f32 v60, v60
    v_rcp_f32 v61, v61
    v_rcp_f32 v62, v62
    v_rcp_f32 v63, v63
    v_rcp_f32 v64, v64
    v_rcp_f32 v65, v65
    v_rcp_f32 v66, v66
    v_rcp_f32 v67, v67
    v_pk_mul_f32 v[52:53], v[52:53], v[60:61]
    v_pk_mul_f32 v[54:55], v[54:55], v[62:63]
    v_pk_mul_f32 v[56:57], v[56:57], v[64:65]
    v_pk_mul_f32 v[58:59], v[58:59], v[66:67]
    v_cvt_pk_bf16_f32 v76, v52, v53
    v_cvt_pk_bf16_f32 v77, v54, v55
    v_cvt_pk_bf16_f32 v78, v56, v57
    v_cvt_pk_bf16_f32 v79, v58, v59
    s_nop 0
    v_permlane32_swap_b32 v76, v78
    v_permlane32_swap_b32 v77, v79
    s_nop 0
    v_permlane16_swap_b32 v76, v78
    v_permlane16_swap_b32 v77, v79
    s_cmp_eq_u32 s96, 0
    s_cbranch_scc1 L_slow_29
    buffer_store_dwordx4 v[76:79], v4, s[40:43], s73 offen offset:3072
    s_branch L_stdone_30
L_slow_29:
    buffer_store_dwordx4 v[76:79], v4, s[40:43], s73 offen offset:3072 sc0 sc1
L_stdone_30:
    s_add_u32 s95, s82, s70
    buffer_load_dwordx4 a[32:35], v4, s[40:43], s95 offen offset:0 sc1
    s_add_u32 s95, s83, s70
    buffer_load_dwordx4 a[36:39], v4, s[40:43], s95 offen offset:0 sc1
    s_add_u32 s95, s82, s70
    buffer_load_dwordx4 a[40:43], v4, s[40:43], s95 offen offset:1024 sc1
    s_add_u32 s95, s83, s70
    buffer_load_dwordx4 a[44:47], v4, s[40:43], s95 offen offset:1024 sc1
    s_add_u32 s95, s82, s71
    buffer_load_dwordx4 a[48:51], v4, s[40:43], s95 offen offset:0 sc1
    s_add_u32 s95, s83, s71
    buffer_load_dwordx4 a[52:55], v4, s[40:43], s95 offen offset:0 sc1
    s_add_u32 s95, s82, s71
    buffer_load_dwordx4 a[56:59], v4, s[40:43], s95 offen offset:1024 sc1
    s_waitcnt vmcnt(10)
    v_mov_b32 v92, 0
    v_mov_b32 v93, 0
    v_mov_b32 v94, 0
    v_mov_b32 v95, 0
    v_lshlrev_b32 v100, 16, v26
    v_alignbit_b32 v101, v27, v26, 16
    v_mov_b32 v98, 0
    v_mov_b32 v99, 0
    v_cmp_eq_u32 vcc, 1, v1
    s_nop 1
    v_cndmask_b32 v99, v99, v100, vcc
    v_cmp_eq_u32 vcc, 2, v1
    s_nop 1
    v_cndmask_b32 v99, v99, v26, vcc
    v_cmp_eq_u32 vcc, 3, v1
    s_nop 1
    v_cndmask_b32 v99, v99, v101, vcc
    v_cndmask_b32 v98, v98, v100, vcc
    v_mov_b32 v96, 0
    v_mov_b32 v97, 0
    v_mul_u32_u24 v102, 4160, v1
    v_add_u32 v102, s87, v102
    v_add_u32 v103, s85, v4
    v_add_u32 v103, 4096, v103
    s_cmp_lg_u32 s7, 0
    s_cbranch_scc1 L_cvfront_31
    s_mov_b64 exec, 15
    ds_write_b128 v102, v[92:95]
    ds_write_b128 v102, v[96:99] offset:16
    s_mov_b32 exec_lo, -1
    s_mov_b32 exec_hi, 0
    ds_write_b128 v103, v[92:95]
    s_mov_b64 exec, -1
L_cvfront_31:
    s_waitcnt vmcnt(7) lgkmcnt(0)
    s_branch L_g3J_22
L_g3B_21:
    s_waitcnt vmcnt(2)
    s_barrier
    ds_read_b128 v[60:63], v112 offset:0
    ds_read_b128 v[64:67], v112 offset:1024
    ds_read_b128 v[68:71], v113 offset:0
    ds_read_b128 v[72:75], v113 offset:1024
    s_waitcnt lgkmcnt(3)
    v_mfma_f32_16x16x32_bf16 v[28:31], a[0:3], v[60:63], 0
    ds_read_b128 v[76:79], v112 offset:4096
    s_waitcnt lgkmcnt(3)
    v_mfma_f32_16x16x32_bf16 v[32:35], a[0:3], v[64:67], 0
    ds_read_b128 v[80:83], v112 offset:5120
    s_waitcnt lgkmcnt(3)
    v_mfma_f32_16x16x32_bf16 v[36:39], a[0:3], v[68:71], 0
    ds_read_b128 v[84:87], v113 offset:4096
    s_waitcnt lgkmcnt(3)
    v_mfma_f32_16x16x32_bf16 v[40:43], a[0:3], v[72:75], 0
    ds_read_b128 v[88:91], v113 offset:5120
    v_mfma_f32_16x16x32_bf16 v[44:47], a[4:7], v[60:63], 0
    s_lshl_b32 s94, s97, 2
    s_add_u32 s94, s94, 32768
    s_and_b32 s94, s94, 0xffff
    s_add_u32 s94, s94, s74
    s_add_u32 m0, s73, 32768
    s_add_u32 s95, s94, 3145728
    buffer_load_dwordx4 v4, s[40:43], s95 offen sc1 lds
    buffer_load_dwordx4 v4, s[40:43], s95 offen offset:1024 sc1 lds
    v_mfma_f32_16x16x32_bf16 v[48:51], a[4:7], v[64:67], 0
    s_waitcnt lgkmcnt(3)
    v_mfma_f32_16x16x32_bf16 v[28:31], a[8:11], v[76:79], v[28:31]
    ds_read_b128 v[60:63], v112 offset:8192
    s_waitcnt lgkmcnt(3)
    v_mfma_f32_16x16x32_bf16 v[32:35], a[8:11], v[80:83], v[32:35]
    ds_read_b128 v[64:67], v112 offset:9216
    s_waitcnt lgkmcnt(3)
    v_mfma_f32_16x16x32_bf16 v[36:39], a[8:11], v[84:87], v[36:39]
    ds_read_b128 v[68:71], v113 offset:8192
    s_waitcnt lgkmcnt(3)
    v_mfma_f32_16x16x32_bf16 v[40:43], a[8:11], v[88:91], v[40:43]
    ds_read_b128 v[72:75], v113 offset:9216
    v_mfma_f32_16x16x32_bf16 v[44:47], a[12:15], v[76:79], v[44:47]
    s_add_u32 s95, s97, 12288
    s_and_b32 s95, s95, 0x3fff
    s_add_u32 s95, s95, s72
    buffer_load_dwordx4 a[96:99], v4, s[40:43], s95 offen offset:0 sc1
    s_add_u32 s95, s97, 12288
    s_and_b32 s95, s95, 0x3fff
    s_add_u32 s95, s95, s81
    buffer_load_dwordx4 a[100:103], v4, s[40:43], s95 offen offset:0 sc1
    v_mfma_f32_16x16x32_bf16 v[48:51], a[12:15], v[80:83], v[48:51]
    s_waitcnt lgkmcnt(3)
    v_mfma_f32_16x16x32_bf16 v[28:31], a[16:19], v[60:63], v[28:31]
    ds_read_b128 v[76:79], v112 offset:12288
    s_waitcnt lgkmcnt(3)
    v_mfma_f32_16x16x32_bf16 v[32:35], a[16:19], v[64:67], v[32:35]
    ds_read_b128 v[80:83], v112 offset:13312
    s_waitcnt lgkmcnt(3)
    v_mfma_f32_16x16x32_bf16 v[36:39], a[16:19], v[68:71], v[36:39]
    ds_read_b128 v[84:87], v113 offset:12288
    s_waitcnt lgkmcnt(3)
    v_mfma_f32_16x16x32_bf16 v[40:43], a[16:19], v[72:75], v[40:43]
    ds_read_b128 v[88:91], v113 offset:13312
    v_mfma_f32_16x16x32_bf16 v[44:47], a[20:23], v[60:63], v[44:47]
    s_lshl_b32 s94, s97, 2
    s_add_u32 s94, s94, 49152
    s_and_b32 s94, s94, 0xffff
    s_add_u32 s94, s94, s74
    s_add_u32 m0, s73, 49152
    s_add_u32 s95, s94, 3145728
    buffer_load_dwordx4 v4, s[40:43], s95 offen sc1 lds
    buffer_load_dwordx4 v4, s[40:43], s95 offen offset:1024 sc1 lds
    v_mfma_f32_16x16x32_bf16 v[48:51], a[20:23], v[64:67], v[48:51]
    s_waitcnt vmcnt(6)
    s_barrier
    s_waitcnt lgkmcnt(3)
    v_mfma_f32_16x16x32_bf16 v[28:31], a[24:27], v[76:79], v[28:31]
    ds_read_b128 v[60:63], v112 offset:16384
    s_waitcnt lgkmcnt(3)
    v_mfma_f32_16x16x32_bf16 v[32:35], a[24:27], v[80:83], v[32:35]
    ds_read_b128 v[64:67], v112 offset:17408
    s_waitcnt lgkmcnt(3)
    v_mfma_f32_16x16x32_bf16 v[36:39], a[24:27], v[84:87], v[36:39]
    ds_read_b128 v[68:71], v113 offset:16384
    s_waitcnt lgkmcnt(3)
    v_mfma_f32_16x16x32_bf16 v[40:43], a[24:27], v[88:91], v[40:43]
    ds_read_b128 v[72:75], v113 offset:17408
    v_mfma_f32_16x16x32_bf16 v[44:47], a[28:31], v[76:79], v[44:47]
    s_add_u32 s95, s97, 12288
    s_and_b32 s95, s95, 0x3fff
    s_add_u32 s95, s95, s72
    buffer_load_dwordx4 a[104:107], v4, s[40:43], s95 offen offset:1024 sc1
    s_add_u32 s95, s97, 12288
    s_and_b32 s95, s95, 0x3fff
    s_add_u32 s95, s95, s81
    buffer_load_dwordx4 a[108:111], v4, s[40:43], s95 offen offset:1024 sc1
    v_mfma_f32_16x16x32_bf16 v[48:51], a[28:31], v[80:83], v[48:51]
    s_waitcnt lgkmcnt(3)
    v_mfma_f32_16x16x32_bf16 v[28:31], a[32:35], v[60:63], v[28:31]
    ds_read_b128 v[76:79], v112 offset:20480
    s_waitcnt lgkmcnt(3)
    v_mfma_f32_16x16x32_bf16 v[32:35], a[32:35], v[64:67], v[32:35]
    ds_read_b128 v[80:83], v112 offset:21504
    s_waitcnt lgkmcnt(3)
    v_mfma_f32_16x16x32_bf16 v[36:39], a[32:35], v[68:71], v[36:39]
    ds_read_b128 v[84:87], v113 offset:20480
    s_waitcnt lgkmcnt(3)
    v_mfma_f32_16x16x32_bf16 v[40:43], a[32:35], v[72:75], v[40:43]
    ds_read_b128 v[88:91], v113 offset:21504
    v_mfma_f32_16x16x32_bf16 v[44:47], a[36:39], v[60:63], v[44:47]
    s_add_u32 s95, s97, 12288
    s_and_b32 s95, s95, 0x3fff
    s_add_u32 s95, s95, s72
    buffer_load_dwordx4 a[112:115], v4, s[40:43], s95 offen offset:2048 sc1
    s_add_u32 s95, s97, 12288
    s_and_b32 s95, s95, 0x3fff
    s_add_u32 s95, s95, s81
    buffer_load_dwordx4 a[116:119], v4, s[40:43], s95 offen offset:2048 sc1
    v_mfma_f32_16x16x32_bf16 v[48:51], a[36:39], v[64:67], v[48:51]
    s_waitcnt lgkmcnt(3)
    v_mfma_f32_16x16x32_bf16 v[28:31], a[40:43], v[76:79], v[28:31]
    ds_read_b128 v[60:63], v112 offset:24576
    s_waitcnt lgkmcnt(3)
    v_mfma_f32_16x16x32_bf16 v[32:35], a[40:43], v[80:83], v[32:35]
    ds_read_b128 v[64:67], v112 offset:25600
    s_waitcnt lgkmcnt(3)
    v_mfma_f32_16x16x32_bf16 v[36:39], a[40:43], v[84:87], v[36:39]
    ds_read_b128 v[68:71], v113 offset:24576
    s_waitcnt lgkmcnt(3)
    v_mfma_f32_16x16x32_bf16 v[40:43], a[40:43], v[88:91], v[40:43]
    ds_read_b128 v[72:75], v113 offset:25600
    v_mfma_f32_16x16x32_bf16 v[44:47], a[44:47], v[76:79], v[44:47]
    s_add_u32 s95, s97, 12288
    s_and_b32 s95, s95, 0x3fff
    s_add_u32 s95, s95, s72
    buffer_load_dwordx4 a[120:123], v4, s[40:43], s95 offen offset:3072 sc1
    s_add_u32 s95, s97, 12288
    s_and_b32 s95, s95, 0x3fff
    s_add_u32 s95, s95, s81
    buffer_load_dwordx4 a[124:127], v4, s[40:43], s95 offen offset:3072 sc1
    v_mfma_f32_16x16x32_bf16 v[48:51], a[44:47], v[80:83], v[48:51]
    s_waitcnt lgkmcnt(3)
    v_mfma_f32_16x16x32_bf16 v[28:31], a[48:51], v[60:63], v[28:31]
    ds_read_b128 v[76:79], v112 offset:28672
    s_waitcnt lgkmcnt(3)
    v_mfma_f32_16x16x32_bf16 v[32:35], a[48:51], v[64:67], v[32:35]
    ds_read_b128 v[80:83], v112 offset:29696
    s_waitcnt lgkmcnt(3)
    v_mfma_f32_16x16x32_bf16 v[36:39], a[48:51], v[68:71], v[36:39]
    ds_read_b128 v[84:87], v113 offset:28672
    s_waitcnt lgkmcnt(3)
    v_mfma_f32_16x16x32_bf16 v[40:43], a[48:51], v[72:75], v[40:43]
    ds_read_b128 v[88:91], v113 offset:29696
    v_mfma_f32_16x16x32_bf16 v[44:47], a[52:55], v[60:63], v[44:47]
    v_lshlrev_b32 v114, 6, v2
    v_lshl_add_u32 v114, v3, 4, v114
    v_mfma_f32_16x16x32_bf16 v[48:51], a[52:55], v[64:67], v[48:51]
    s_sub_u32 s95, s72, 0x1400000
    s_lshr_b32 s95, s95, 4
    s_add_u32 s95, s95, 0x520000
    buffer_load_dwordx4 v[120:123], v114, s[40:43], s95 offen sc1
    s_sub_u32 s95, s81, 0x1400000
    s_lshr_b32 s95, s95, 4
    s_add_u32 s95, s95, 0x520000
    buffer_load_dwordx4 v[124:127], v114, s[40:43], s95 offen sc1
    s_waitcnt vmcnt(12)
    s_waitcnt lgkmcnt(0)
    s_barrier
    v_mfma_f32_16x16x32_bf16 v[28:31], a[56:59], v[76:79], v[28:31]
    ds_read_b128 v[60:63], v112 offset:32768
    v_mfma_f32_16x16x32_bf16 v[32:35], a[56:59], v[80:83], v[32:35]
    ds_read_b128 v[64:67], v112 offset:33792
    v_mfma_f32_16x16x32_bf16 v[36:39], a[56:59], v[84:87], v[36:39]
    ds_read_b128 v[68:71], v113 offset:32768
    v_mfma_f32_16x16x32_bf16 v[40:43], a[56:59], v[88:91], v[40:43]
    ds_read_b128 v[72:75], v113 offset:33792
    v_mfma_f32_16x16x32_bf16 v[44:47], a[60:63], v[76:79], v[44:47]
    v_mfma_f32_16x16x32_bf16 v[48:51], a[60:63], v[80:83], v[48:51]
    s_waitcnt lgkmcnt(3)
    v_mfma_f32_16x16x32_bf16 v[28:31], a[64:67], v[60:63], v[28:31]
    ds_read_b128 v[76:79], v112 offset:36864
    s_waitcnt lgkmcnt(3)
    v_mfma_f32_16x16x32_bf16 v[32:35], a[64:67], v[64:67], v[32:35]
    ds_read_b128 v[80:83], v112 offset:37888
    s_waitcnt lgkmcnt(3)
    v_mfma_f32_16x16x32_bf16 v[36:39], a[64:67], v[68:71], v[36:39]
    ds_read_b128 v[84:87], v113 offset:36864
    s_waitcnt lgkmcnt(3)
    v_mfma_f32_16x16x32_bf16 v[40:43], a[64:67], v[72:75], v[40:43]
    ds_read_b128 v[88:91], v113 offset:37888
    v_mfma_f32_16x16x32_bf16 v[44:47], a[68:71], v[60:63], v[44:47]
    s_add_u32 s95, s82, s68
    buffer_load_dwordx4 a[0:3], v4, s[40:43], s95 offen offset:0 sc1
    v_mfma_f32_16x16x32_bf16 v[48:51], a[68:71], v[64:67], v[48:51]
    s_waitcnt lgkmcnt(3)
    v_mfma_f32_16x16x32_bf16 v[28:31], a[72:75], v[76:79], v[28:31]
    ds_read_b128 v[60:63], v112 offset:40960
    s_waitcnt lgkmcnt(3)
    v_mfma_f32_16x16x32_bf16 v[32:35], a[72:75], v[80:83], v[32:35]
    ds_read_b128 v[64:67], v112 offset:41984
    s_waitcnt lgkmcnt(3)
    v_mfma_f32_16x16x32_bf16 v[36:39], a[72:75], v[84:87], v[36:39]
    ds_read_b128 v[68:71], v113 offset:40960
    s_waitcnt lgkmcnt(3)
    v_mfma_f32_16x16x32_bf16 v[40:43], a[72:75], v[88:91], v[40:43]
    ds_read_b128 v[72:75], v113 offset:41984
    v_mfma_f32_16x16x32_bf16 v[44:47], a[76:79], v[76:79], v[44:47]
    s_add_u32 s95, s83, s68
    buffer_load_dwordx4 a[4:7], v4, s[40:43], s95 offen offset:0 sc1
    v_mfma_f32_16x16x32_bf16 v[48:51], a[76:79], v[80:83], v[48:51]
    s_waitcnt lgkmcnt(3)
    v_mfma_f32_16x16x32_bf16 v[28:31], a[80:83], v[60:63], v[28:31]
    ds_read_b128 v[76:79], v112 offset:45056
    s_waitcnt lgkmcnt(3)
    v_mfma_f32_16x16x32_bf16 v[32:35], a[80:83], v[64:67], v[32:35]
    ds_read_b128 v[80:83], v112 offset:46080
    s_waitcnt lgkmcnt(3)
    v_mfma_f32_16x16x32_bf16 v[36:39], a[80:83], v[68:71], v[36:39]
    ds_read_b128 v[84:87], v113 offset:45056
    s_waitcnt lgkmcnt(3)
    v_mfma_f32_16x16x32_bf16 v[40:43], a[80:83], v[72:75], v[40:43]
    ds_read_b128 v[88:91], v113 offset:46080
    v_mfma_f32_16x16x32_bf16 v[44:47], a[84:87], v[60:63], v[44:47]
    s_add_u32 s95, s82, s68
    buffer_load_dwordx4 a[8:11], v4, s[40:43], s95 offen offset:1024 sc1
    v_mfma_f32_16x16x32_bf16 v[48:51], a[84:87], v[64:67], v[48:51]
    s_waitcnt vmcnt(11)
    s_waitcnt lgkmcnt(0)
    s_barrier
    v_mfma_f32_16x16x32_bf16 v[28:31], a[88:91], v[76:79], v[28:31]
    ds_read_b128 v[60:63], v112 offset:49152
    v_mfma_f32_16x16x32_bf16 v[32:35], a[88:91], v[80:83], v[32:35]
    ds_read_b128 v[64:67], v112 offset:50176
    v_mfma_f32_16x16x32_bf16 v[36:39], a[88:91], v[84:87], v[36:39]
    ds_read_b128 v[68:71], v113 offset:49152
    v_mfma_f32_16x16x32_bf16 v[40:43], a[88:91], v[88:91], v[40:43]
    ds_read_b128 v[72:75], v113 offset:50176
    v_mfma_f32_16x16x32_bf16 v[44:47], a[92:95], v[76:79], v[44:47]
    s_add_u32 s95, s83, s68
    buffer_load_dwordx4 a[12:15], v4, s[40:43], s95 offen offset:1024 sc1
    v_lshlrev_b32 v108, 3, v1
    v_mfma_f32_16x16x32_bf16 v[48:51], a[92:95], v[80:83], v[48:51]
    ds_read_b64 v[92:93], v108 offset:0
    ds_read_b64 v[94:95], v108 offset:512
    ds_read_b64 v[96:97], v108 offset:1024
    ds_read_b64 v[98:99], v108 offset:1536
    ds_read_b64 v[100:101], v108 offset:2048
    ds_read_b64 v[102:103], v108 offset:2560
    ds_read_b64 v[104:105], v108 offset:3072
    ds_read_b64 v[106:107], v108 offset:3584
    s_lshr_b32 s88, s76, 4
    v_lshlrev_b32 v114, 2, v2
    v_add_u32 v118, s88, v114
    s_lshr_b32 s88, s77, 4
    v_add_u32 v119, s88, v114
    s_waitcnt lgkmcnt(0)
    s_waitcnt vmcnt(6)
    v_mfma_f32_16x16x32_bf16 v[28:31], a[96:99], v[60:63], v[28:31]
    ds_read_b128 v[76:79], v112 offset:53248
    v_mfma_f32_16x16x32_bf16 v[32:35], a[96:99], v[64:67], v[32:35]
    ds_read_b128 v[80:83], v112 offset:54272
    v_mfma_f32_16x16x32_bf16 v[36:39], a[96:99], v[68:71], v[36:39]
    ds_read_b128 v[84:87], v113 offset:53248
    v_mfma_f32_16x16x32_bf16 v[40:43], a[96:99], v[72:75], v[40:43]
    ds_read_b128 v[88:91], v113 offset:54272
    v_mfma_f32_16x16x32_bf16 v[44:47], a[100:103], v[60:63], v[44:47]
    s_add_u32 s95, s82, s69
    buffer_load_dwordx4 a[16:19], v4, s[40:43], s95 offen offset:0 sc1
    s_waitcnt vmcnt(5)
    v_mfma_f32_16x16x32_bf16 v[48:51], a[100:103], v[64:67], v[48:51]
    v_add_f32_dpp v120, v120, v120 row_ror:1 row_mask:0xf bank_mask:0xf
    v_add_f32_dpp v121, v121, v121 row_ror:1 row_mask:0xf bank_mask:0xf
    v_add_f32_dpp v122, v122, v122 row_ror:1 row_mask:0xf bank_mask:0xf
    v_add_f32_dpp v123, v123, v123 row_ror:1 row_mask:0xf bank_mask:0xf
    v_add_f32_dpp v124, v124, v124 row_ror:1 row_mask:0xf bank_mask:0xf
    v_add_f32_dpp v125, v125, v125 row_ror:1 row_mask:0xf bank_mask:0xf
    v_add_f32_dpp v126, v126, v126 row_ror:1 row_mask:0xf bank_mask:0xf
    v_add_f32_dpp v127, v127, v127 row_ror:1 row_mask:0xf bank_mask:0xf
    v_add_f32 v92, v92, v94
    v_add_f32 v93, v93, v95
    v_add_f32 v96, v96, v98
    v_add_f32 v97, v97, v99
    v_add_f32 v100, v100, v102
    v_add_f32 v101, v101, v103
    v_add_f32 v104, v104, v106
    v_add_f32 v105, v105, v107
    v_add_f32 v92, v92, v96
    v_add_f32 v93, v93, v97
    v_add_f32 v100, v100, v104
    v_add_f32 v101, v101, v105
    v_add_f32 v92, v92, v100
    v_add_f32 v93, v93, v101
    v_mul_f32 v94, 0x3b000000, v92
    s_waitcnt lgkmcnt(3)
    v_mfma_f32_16x16x32_bf16 v[28:31], a[104:107], v[76:79], v[28:31]
    ds_read_b128 v[60:63], v112 offset:57344
    s_waitcnt lgkmcnt(3)
    v_mfma_f32_16x16x32_bf16 v[32:35], a[104:107], v[80:83], v[32:35]
    ds_read_b128 v[64:67], v112 offset:58368
    s_waitcnt lgkmcnt(3)
    v_mfma_f32_16x16x32_bf16 v[36:39], a[104:107], v[84:87], v[36:39]
    ds_read_b128 v[68:71], v113 offset:57344
    s_waitcnt lgkmcnt(3)
    v_mfma_f32_16x16x32_bf16 v[40:43], a[104:107], v[88:91], v[40:43]
    ds_read_b128 v[72:75], v113 offset:58368
    v_mfma_f32_16x16x32_bf16 v[44:47], a[108:111], v[76:79], v[44:47]
    s_add_u32 s95, s83, s69
    buffer_load_dwordx4 a[20:23], v4, s[40:43], s95 offen offset:0 sc1
    v_add_f32_dpp v120, v120, v120 row_ror:2 row_mask:0xf bank_mask:0xf
    v_mfma_f32_16x16x32_bf16 v[48:51], a[108:111], v[80:83], v[48:51]
    v_add_f32_dpp v121, v121, v121 row_ror:2 row_mask:0xf bank_mask:0xf
    v_add_f32_dpp v122, v122, v122 row_ror:2 row_mask:0xf bank_mask:0xf
    v_add_f32_dpp v123, v123, v123 row_ror:2 row_mask:0xf bank_mask:0xf
    v_add_f32_dpp v124, v124, v124 row_ror:2 row_mask:0xf bank_mask:0xf
    v_add_f32_dpp v125, v125, v125 row_ror:2 row_mask:0xf bank_mask:0xf
    v_add_f32_dpp v126, v126, v126 row_ror:2 row_mask:0xf bank_mask:0xf
    v_add_f32_dpp v127, v127, v127 row_ror:2 row_mask:0xf bank_mask:0xf
    v_add_f32_dpp v120, v120, v120 row_ror:4 row_mask:0xf bank_mask:0xf
    v_add_f32_dpp v121, v121, v121 row_ror:4 row_mask:0xf bank_mask:0xf
    v_add_f32_dpp v122, v122, v122 row_ror:4 row_mask:0xf bank_mask:0xf
    v_add_f32_dpp v123, v123, v123 row_ror:4 row_mask:0xf bank_mask:0xf
    v_mul_f32 v95, 0x3b000000, v93
    v_fma_f32 v95, -v94, v94, v95
    v_max_f32 v95, 0, v95
    v_add_f32 v95, 0x3727c5ac, v95
    v_rsq_f32 v96, v95
    v_sqrt_f32 v111, v95
    v_sub_f32 v108, 0, v94
    v_mul_f32 v109, 0xc0135761, v96
    v_mul_f32 v97, v96, v96
    v_mul_f32 v97, v97, v96
    v_mul_f32 v110, 0xbdd2d3e8, v97
    ds_bpermute_b32 v92, v118, v108 offset:0
    ds_bpermute_b32 v93, v118, v109 offset:0
    ds_bpermute_b32 v94, v118, v110 offset:0
    ds_bpermute_b32 v95, v118, v111 offset:0
    s_waitcnt lgkmcnt(7)
    v_mfma_f32_16x16x32_bf16 v[28:31], a[112:115], v[60:63], v[28:31]
    ds_read_b128 v[76:79], v112 offset:61440
    s_waitcnt lgkmcnt(7)
    v_mfma_f32_16x16x32_bf16 v[32:35], a[112:115], v[64:67], v[32:35]
    ds_read_b128 v[80:83], v112 offset:62464
    s_waitcnt lgkmcnt(7)
    v_mfma_f32_16x16x32_bf16 v[36:39], a[112:115], v[68:71], v[36:39]
    ds_read_b128 v[84:87], v113 offset:61440
    s_waitcnt lgkmcnt(7)
    v_mfma_f32_16x16x32_bf16 v[40:43], a[112:115], v[72:75], v[40:43]
    ds_read_b128 v[88:91], v113 offset:62464
    v_mfma_f32_16x16x32_bf16 v[44:47], a[116:119], v[60:63], v[44:47]
    s_add_u32 s95, s82, s69
    buffer_load_dwordx4 a[24:27], v4, s[40:43], s95 offen offset:1024 sc1
    v_add_f32_dpp v124, v124, v124 row_ror:4 row_mask:0xf bank_mask:0xf
    v_mfma_f32_16x16x32_bf16 v[48:51], a[116:119], v[64:67], v[48:51]
    v_add_f32_dpp v125, v125, v125 row_ror:4 row_mask:0xf bank_mask:0xf
    v_add_f32_dpp v126, v126, v126 row_ror:4 row_mask:0xf bank_mask:0xf
    v_add_f32_dpp v127, v127, v127 row_ror:4 row_mask:0xf bank_mask:0xf
    v_add_f32_dpp v120, v120, v120 row_ror:8 row_mask:0xf bank_mask:0xf
    v_add_f32_dpp v121, v121, v121 row_ror:8 row_mask:0xf bank_mask:0xf
    v_add_f32_dpp v122, v122, v122 row_ror:8 row_mask:0xf bank_mask:0xf
    v_add_f32_dpp v123, v123, v123 row_ror:8 row_mask:0xf bank_mask:0xf
    v_add_f32_dpp v124, v124, v124 row_ror:8 row_mask:0xf bank_mask:0xf
    v_add_f32_dpp v125, v125, v125 row_ror:8 row_mask:0xf bank_mask:0xf
    v_add_f32_dpp v126, v126, v126 row_ror:8 row_mask:0xf bank_mask:0xf
    v_add_f32_dpp v127, v127, v127 row_ror:8 row_mask:0xf bank_mask:0xf
    ds_bpermute_b32 v96, v118, v108 offset:64
    ds_bpermute_b32 v97, v118, v109 offset:64
    ds_bpermute_b32 v98, v118, v110 offset:64
    ds_bpermute_b32 v99, v118, v111 offset:64
    ds_bpermute_b32 v100, v119, v108 offset:0
    ds_bpermute_b32 v101, v119, v109 offset:0
    ds_bpermute_b32 v102, v119, v110 offset:0
    ds_bpermute_b32 v103, v119, v111 offset:0
    ds_bpermute_b32 v104, v119, v108 offset:64
    ds_bpermute_b32 v105, v119, v109 offset:64
    ds_bpermute_b32 v106, v119, v110 offset:64
    ds_bpermute_b32 v107, v119, v111 offset:64
    s_waitcnt lgkmcnt(15)
    v_mfma_f32_16x16x32_bf16 v[28:31], a[120:123], v[76:79], v[28:31]
    s_add_u32 s95, s83, s69
    buffer_load_dwordx4 a[28:31], v4, s[40:43], s95 offen offset:1024 sc1
    s_waitcnt lgkmcnt(14)
    v_mfma_f32_16x16x32_bf16 v[32:35], a[120:123], v[80:83], v[32:35]
    s_waitcnt lgkmcnt(13)
    v_mfma_f32_16x16x32_bf16 v[36:39], a[120:123], v[84:87], v[36:39]
    s_waitcnt lgkmcnt(12)
    v_mfma_f32_16x16x32_bf16 v[40:43], a[120:123], v[88:91], v[40:43]
    v_mfma_f32_16x16x32_bf16 v[44:47], a[124:127], v[76:79], v[44:47]
    v_mfma_f32_16x16x32_bf16 v[48:51], a[124:127], v[80:83], v[48:51]
    s_lshr_b32 s93, s7, 1
    s_lshl_b32 s94, s93, 12
    s_add_u32 s73, s75, s94
    s_and_b32 s94, s7, 1
    s_lshl_b32 s94, s94, 9
    s_add_u32 s73, s73, s94
    s_add_u32 s73, s73, 16384
    s_lshl_b32 s93, s93, 9
    s_add_u32 s74, s75, s93
    s_add_u32 s74, s74, 24576
    s_add_u32 s74, s74, s76
    s_add_u32 s94, s73, s77
    s_add_u32 s73, s73, s76
    s_mov_b32 s75, s94
    s_waitcnt lgkmcnt(0)
    v_fma_f32 v28, v120, v92, v28
    v_fma_f32 v29, v121, v92, v29
    v_fma_f32 v30, v122, v92, v30
    v_fma_f32 v31, v123, v92, v31
    v_pk_mul_f32 v[60:61], v[28:29], v[28:29]
    v_pk_mul_f32 v[62:63], v[30:31], v[30:31]
    v_fma_f32 v60, v60, v94, v93
    v_fma_f32 v61, v61, v94, v93
    v_fma_f32 v62, v62, v94, v93
    v_fma_f32 v63, v63, v94, v93
    v_pk_mul_f32 v[60:61], v[60:61], v[28:29]
    v_pk_mul_f32 v[62:63], v[62:63], v[30:31]
    v_exp_f32 v60, v60
    v_exp_f32 v61, v61
    v_exp_f32 v62, v62
    v_exp_f32 v63, v63
    v_fma_f32 v60, v60, v95, v95
    v_fma_f32 v61, v61, v95, v95
    v_fma_f32 v62, v62, v95, v95
    v_fma_f32 v63, v63, v95, v95
    v_rcp_f32 v60, v60
    v_rcp_f32 v61, v61
    v_rcp_f32 v62, v62
    v_rcp_f32 v63, v63
    v_pk_mul_f32 v[28:29], v[28:29], v[60:61]
    v_pk_mul_f32 v[30:31], v[30:31], v[62:63]
    v_fma_f32 v32, v120, v96, v32
    v_fma_f32 v33, v121, v96, v33
    v_fma_f32 v34, v122, v96, v34
    v_fma_f32 v35, v123, v96, v35
    v_pk_mul_f32 v[64:65], v[32:33], v[32:33]
    v_pk_mul_f32 v[66:67], v[34:35], v[34:35]
    v_fma_f32 v64, v64, v98, v97
    v_fma_f32 v65, v65, v98, v97
    v_fma_f32 v66, v66, v98, v97
    v_fma_f32 v67, v67, v98, v97
    v_pk_mul_f32 v[64:65], v[64:65], v[32:33]
    v_pk_mul_f32 v[66:67], v[66:67], v[34:35]
    v_exp_f32 v64, v64
    v_exp_f32 v65, v65
    v_exp_f32 v66, v66
    v_exp_f32 v67, v67
    v_fma_f32 v64, v64, v99, v99
    v_fma_f32 v65, v65, v99, v99
    v_fma_f32 v66, v66, v99, v99
    v_fma_f32 v67, v67, v99, v99
    v_rcp_f32 v64, v64
    v_rcp_f32 v65, v65
    v_rcp_f32 v66, v66
    v_rcp_f32 v67, v67
    v_pk_mul_f32 v[32:33], v[32:33], v[64:65]
    v_pk_mul_f32 v[34:35], v[34:35], v[66:67]
    v_cvt_pk_bf16_f32 v76, v28, v29
    v_cvt_pk_bf16_f32 v77, v30, v31
    v_cvt_pk_bf16_f32 v78, v32, v33
    v_cvt_pk_bf16_f32 v79, v34, v35
    s_nop 0
    v_permlane32_swap_b32 v76, v78
    v_permlane32_swap_b32 v77, v79
    s_nop 0
    v_permlane16_swap_b32 v76, v78
    v_permlane16_swap_b32 v77, v79
    s_cmp_eq_u32 s96, 0
    s_cbranch_scc1 L_slow_32
    buffer_store_dwordx4 v[76:79], v7, s[40:43], s73 offen
    s_branch L_stdone_33
L_slow_32:
    buffer_store_dwordx4 v[76:79], v7, s[40:43], s73 offen sc0 sc1
L_stdone_33:
    s_lshl_b32 s89, s7, 10
    s_add_u32 s88, s86, s89
    s_add_u32 s89, s89, s85
    s_add_u32 m0, s89, 0
    s_add_u32 s95, s88, 6291456
    buffer_load_dwordx4 v4, s[40:43], s95 offen sc1 lds
    s_mul_i32 s90, s7, 4160
    s_add_u32 s90, s90, s87
    s_lshl_b32 s89, s7, 1
    s_add_u32 s89, s89, s86
    s_add_u32 m0, s90, 32
    s_nop 0
    buffer_load_dwordx4 v4, s[44:47], s89 offen  lds
    buffer_load_dwordx4 v4, s[44:47], s89 offen offset:1024  lds
    buffer_load_dwordx4 v4, s[44:47], s89 offen offset:2048  lds
    buffer_load_dwordx4 v4, s[44:47], s89 offen offset:3072  lds
    v_mov_b32 v25, s86
    buffer_load_dwordx2 v[26:27], v25, s[44:47], 0 offen
    v_fma_f32 v36, v120, v100, v36
    v_fma_f32 v37, v121, v100, v37
    v_fma_f32 v38, v122, v100, v38
    v_fma_f32 v39, v123, v100, v39
    v_pk_mul_f32 v[60:61], v[36:37], v[36:37]
    v_pk_mul_f32 v[62:63], v[38:39], v[38:39]
    v_fma_f32 v60, v60, v102, v101
    v_fma_f32 v61, v61, v102, v101
    v_fma_f32 v62, v62, v102, v101
    v_fma_f32 v63, v63, v102, v101
    v_pk_mul_f32 v[60:61], v[60:61], v[36:37]
    v_pk_mul_f32 v[62:63], v[62:63], v[38:39]
    v_exp_f32 v60, v60
    v_exp_f32 v61, v61
    v_exp_f32 v62, v62
    v_exp_f32 v63, v63
    v_fma_f32 v60, v60, v103, v103
    v_fma_f32 v61, v61, v103, v103
    v_fma_f32 v62, v62, v103, v103
    v_fma_f32 v63, v63, v103, v103
    v_rcp_f32 v60, v60
    v_rcp_f32 v61, v61
    v_rcp_f32 v62, v62
    v_rcp_f32 v63, v63
    v_pk_mul_f32 v[36:37], v[36:37], v[60:61]
    v_pk_mul_f32 v[38:39], v[38:39], v[62:63]
    v_fma_f32 v40, v120, v104, v40
    v_fma_f32 v41, v121, v104, v41
    v_fma_f32 v42, v122, v104, v42
    v_fma_f32 v43, v123, v104, v43
    v_pk_mul_f32 v[64:65], v[40:41], v[40:41]
    v_pk_mul_f32 v[66:67], v[42:43], v[42:43]
    v_fma_f32 v64, v64, v106, v105
    v_fma_f32 v65, v65, v106, v105
    v_fma_f32 v66, v66, v106, v105
    v_fma_f32 v67, v67, v106, v105
    v_pk_mul_f32 v[64:65], v[64:65], v[40:41]
    v_pk_mul_f32 v[66:67], v[66:67], v[42:43]
    v_exp_f32 v64, v64
    v_exp_f32 v65, v65
    v_exp_f32 v66, v66
    v_exp_f32 v67, v67
    v_fma_f32 v64, v64, v107, v107
    v_fma_f32 v65, v65, v107, v107
    v_fma_f32 v66, v66, v107, v107
    v_fma_f32 v67, v67, v107, v107
    v_rcp_f32 v64, v64
    v_rcp_f32 v65, v65
    v_rcp_f32 v66, v66
    v_rcp_f32 v67, v67
    v_pk_mul_f32 v[40:41], v[40:41], v[64:65]
    v_pk_mul_f32 v[42:43], v[42:43], v[66:67]
    v_cvt_pk_bf16_f32 v76, v36, v37
    v_cvt_pk_bf16_f32 v77, v38, v39
    v_cvt_pk_bf16_f32 v78, v40, v41
    v_cvt_pk_bf16_f32 v79, v42, v43
    s_nop 0
    v_permlane32_swap_b32 v76, v78
    v_permlane32_swap_b32 v77, v79
    s_nop 0
    v_permlane16_swap_b32 v76, v78
    v_permlane16_swap_b32 v77, v79
    s_cmp_eq_u32 s96, 0
    s_cbranch_scc1 L_slow_34
    buffer_store_dwordx4 v[76:79], v7, s[40:43], s75 offen
    s_branch L_stdone_35
L_slow_34:
    buffer_store_dwordx4 v[76:79], v7, s[40:43], s75 offen sc0 sc1
L_stdone_35:
    v_fma_f32 v44, v124, v92, v44
    v_fma_f32 v45, v125, v92, v45
    v_fma_f32 v46, v126, v92, v46
    v_fma_f32 v47, v127, v92, v47
    v_pk_mul_f32 v[60:61], v[44:45], v[44:45]
    v_pk_mul_f32 v[62:63], v[46:47], v[46:47]
    v_fma_f32 v60, v60, v94, v93
    v_fma_f32 v61, v61, v94, v93
    v_fma_f32 v62, v62, v94, v93
    v_fma_f32 v63, v63, v94, v93
    v_pk_mul_f32 v[60:61], v[60:61], v[44:45]
    v_pk_mul_f32 v[62:63], v[62:63], v[46:47]
    v_exp_f32 v60, v60
    v_exp_f32 v61, v61
    v_exp_f32 v62, v62
    v_exp_f32 v63, v63
    v_fma_f32 v60, v60, v95, v95
    v_fma_f32 v61, v61, v95, v95
    v_fma_f32 v62, v62, v95, v95
    v_fma_f32 v63, v63, v95, v95
    v_rcp_f32 v60, v60
    v_rcp_f32 v61, v61
    v_rcp_f32 v62, v62
    v_rcp_f32 v63, v63
    v_pk_mul_f32 v[44:45], v[44:45], v[60:61]
    v_pk_mul_f32 v[46:47], v[46:47], v[62:63]
    v_fma_f32 v48, v124, v96, v48
    v_fma_f32 v49, v125, v96, v49
    v_fma_f32 v50, v126, v96, v50
    v_fma_f32 v51, v127, v96, v51
    v_pk_mul_f32 v[64:65], v[48:49], v[48:49]
    v_pk_mul_f32 v[66:67], v[50:51], v[50:51]
    v_fma_f32 v64, v64, v98, v97
    v_fma_f32 v65, v65, v98, v97
    v_fma_f32 v66, v66, v98, v97
    v_fma_f32 v67, v67, v98, v97
    v_pk_mul_f32 v[64:65], v[64:65], v[48:49]
    v_pk_mul_f32 v[66:67], v[66:67], v[50:51]
    v_exp_f32 v64, v64
    v_exp_f32 v65, v65
    v_exp_f32 v66, v66
    v_exp_f32 v67, v67
    v_fma_f32 v64, v64, v99, v99
    v_fma_f32 v65, v65, v99, v99
    v_fma_f32 v66, v66, v99, v99
    v_fma_f32 v67, v67, v99, v99
    v_rcp_f32 v64, v64
    v_rcp_f32 v65, v65
    v_rcp_f32 v66, v66
    v_rcp_f32 v67, v67
    v_pk_mul_f32 v[48:49], v[48:49], v[64:65]
    v_pk_mul_f32 v[50:51], v[50:51], v[66:67]
    v_cvt_pk_bf16_f32 v76, v44, v45
    v_cvt_pk_bf16_f32 v77, v46, v47
    v_cvt_pk_bf16_f32 v78, v48, v49
    v_cvt_pk_bf16_f32 v79, v50, v51
    s_nop 0
    v_permlane32_swap_b32 v76, v78
    v_permlane32_swap_b32 v77, v79
    s_nop 0
    v_permlane16_swap_b32 v76, v78
    v_permlane16_swap_b32 v77, v79
    s_cmp_eq_u32 s96, 0
    s_cbranch_scc1 L_slow_36
    buffer_store_dwordx4 v[76:79], v7, s[40:43], s74 offen
    s_branch L_stdone_37
L_slow_36:
    buffer_store_dwordx4 v[76:79], v7, s[40:43], s74 offen sc0 sc1
L_stdone_37:
    s_add_u32 s95, s82, s70
    buffer_load_dwordx4 a[32:35], v4, s[40:43], s95 offen offset:0 sc1
    s_add_u32 s95, s83, s70
    buffer_load_dwordx4 a[36:39], v4, s[40:43], s95 offen offset:0 sc1
    s_add_u32 s95, s82, s70
    buffer_load_dwordx4 a[40:43], v4, s[40:43], s95 offen offset:1024 sc1
    s_add_u32 s95, s83, s70
    buffer_load_dwordx4 a[44:47], v4, s[40:43], s95 offen offset:1024 sc1
    s_add_u32 s95, s82, s71
    buffer_load_dwordx4 a[48:51], v4, s[40:43], s95 offen offset:0 sc1
    s_add_u32 s95, s83, s71
    buffer_load_dwordx4 a[52:55], v4, s[40:43], s95 offen offset:0 sc1
    s_add_u32 s95, s82, s71
    buffer_load_dwordx4 a[56:59], v4, s[40:43], s95 offen offset:1024 sc1
    s_waitcnt vmcnt(9)
    v_mov_b32 v92, 0
    v_mov_b32 v93, 0
    v_mov_b32 v94, 0
    v_mov_b32 v95, 0
    v_lshlrev_b32 v100, 16, v26
    v_alignbit_b32 v101, v27, v26, 16
    v_mov_b32 v98, 0
    v_mov_b32 v99, 0
    v_cmp_eq_u32 vcc, 1, v1
    s_nop 1
    v_cndmask_b32 v99, v99, v100, vcc
    v_cmp_eq_u32 vcc, 2, v1
    s_nop 1
    v_cndmask_b32 v99, v99, v26, vcc
    v_cmp_eq_u32 vcc, 3, v1
    s_nop 1
    v_cndmask_b32 v99, v99, v101, vcc
    v_cndmask_b32 v98, v98, v100, vcc
    v_mov_b32 v96, 0
    v_mov_b32 v97, 0
    v_mul_u32_u24 v102, 4160, v1
    v_add_u32 v102, s87, v102
    v_add_u32 v103, s85, v4
    v_add_u32 v103, 4096, v103
    s_cmp_lg_u32 s7, 0
    s_cbranch_scc1 L_cvfront_38
    s_mov_b64 exec, 15
    ds_write_b128 v102, v[92:95]
    ds_write_b128 v102, v[96:99] offset:16
    s_mov_b32 exec_lo, -1
    s_mov_b32 exec_hi, 0
    ds_write_b128 v103, v[92:95]
    s_mov_b64 exec, -1
L_cvfront_38:
    s_waitcnt vmcnt(7) lgkmcnt(0)
L_g3J_22:
    s_barrier
    s_cmp_lg_u32 s3, 0
    s_cbranch_scc1 L_sig_39
    s_add_u32 s88, s4, 0
    s_lshl_b32 s88, s88, 7
    s_lshl_b32 s89, s5, 3
    s_add_u32 s88, s88, s89
    s_add_u32 s88, s88, 0x4000
    v_mov_b32 v20, s52
    v_mov_b32 v21, s53
    v_mov_b32 v22, s88
    s_mov_b64 exec, 1
    s_cmp_eq_u32 s96, 0
    s_cbranch_scc1 L_slow_40
    buffer_store_dwordx2 v[20:21], v22, s[40:43], 0 offen
    s_branch L_stdone_41
L_slow_40:
    buffer_store_dwordx2 v[20:21], v22, s[40:43], 0 offen sc0 sc1
L_stdone_41:
    s_mov_b64 exec, -1
L_sig_39:
    v_add_u32 v124, 1, v2
    v_and_b32 v125, 3, v124
    v_sub_u32 v124, v124, v125
    v_lshl_add_u32 v124, v3, 3, v124
    v_lshlrev_b32 v124, 1, v124
    v_mul_u32_u24 v125, 4160, v125
    v_add_u32 v124, v124, v125
    s_lshl_b32 s88, s7, 7
    s_add_u32 s89, s88, s87
    v_add_u32 v124, s89, v124
    v_lshlrev_b32 v125, 4, v3
    v_lshlrev_b32 v126, 5, v2
    v_sub_u32 v125, v125, v126
    s_add_u32 s89, s88, s85
    s_add_u32 s89, s89, 480
    v_add_u32 v125, s89, v125
    ds_read_b64 v[60:61], v124 offset:0
    ds_read_b64 v[62:63], v124 offset:8
    ds_read_b128 v[120:123], v125 offset:0
    ds_read_b64 v[64:65], v124 offset:512
    ds_read_b64 v[66:67], v124 offset:520
    ds_read_b128 v[116:119], v125 offset:512
    ds_read_b64 v[68:69], v124 offset:1024
    ds_read_b64 v[70:71], v124 offset:1032
    ds_read_b128 v[112:115], v125 offset:1024
    ds_read_b64 v[72:73], v124 offset:1536
    ds_read_b64 v[74:75], v124 offset:1544
    ds_read_b128 v[108:111], v125 offset:1536
    ds_read_b64 v[76:77], v124 offset:2048
    ds_read_b64 v[78:79], v124 offset:2056
    ds_read_b128 v[104:107], v125 offset:2048
    ds_read_b64 v[80:81], v124 offset:2560
    ds_read_b64 v[82:83], v124 offset:2568
    ds_read_b128 v[100:103], v125 offset:2560
    ds_read_b64 v[84:85], v124 offset:3072
    ds_read_b64 v[86:87], v124 offset:3080
    ds_read_b128 v[96:99], v125 offset:3072
    ds_read_b64 v[88:89], v124 offset:3584
    ds_read_b64 v[90:91], v124 offset:3592
    ds_read_b128 v[92:95], v125 offset:3584
    v_add_u32 v124, 64, v124
    v_add_u32 v125, 64, v125
    s_waitcnt lgkmcnt(15)
    v_mfma_f32_16x16x32_bf16 v[56:59], v[60:63], v[120:123], 0
    s_waitcnt lgkmcnt(15)
    v_mfma_f32_16x16x32_bf16 v[52:55], v[60:63], v[116:119], 0
    s_waitcnt lgkmcnt(15)
    v_mfma_f32_16x16x32_bf16 v[48:51], v[60:63], v[112:115], 0
    s_add_u32 s95, s83, s71
    buffer_load_dwordx4 a[60:63], v4, s[40:43], s95 offen offset:1024 sc1
    s_waitcnt lgkmcnt(12)
    v_mfma_f32_16x16x32_bf16 v[44:47], v[60:63], v[108:111], 0
    s_waitcnt lgkmcnt(9)
    v_mfma_f32_16x16x32_bf16 v[40:43], v[60:63], v[104:107], 0
    s_waitcnt lgkmcnt(6)
    v_mfma_f32_16x16x32_bf16 v[36:39], v[60:63], v[100:103], 0
    s_add_u32 s95, s82, s99
    buffer_load_dwordx4 a[64:67], v4, s[40:43], s95 offen offset:0 sc1
    s_waitcnt lgkmcnt(3)
    v_mfma_f32_16x16x32_bf16 v[32:35], v[60:63], v[96:99], 0
    s_waitcnt lgkmcnt(0)
    v_mfma_f32_16x16x32_bf16 v[28:31], v[60:63], v[92:95], 0
    v_mfma_f32_16x16x32_bf16 v[56:59], v[64:67], v[116:119], v[56:59]
    ds_read_b64 v[60:61], v124 offset:0
    ds_read_b64 v[62:63], v124 offset:8
    ds_read_b128 v[120:123], v125 offset:0
    s_add_u32 s95, s83, s99
    buffer_load_dwordx4 a[68:71], v4, s[40:43], s95 offen offset:0 sc1
    v_mfma_f32_16x16x32_bf16 v[52:55], v[64:67], v[112:115], v[52:55]
    v_mfma_f32_16x16x32_bf16 v[48:51], v[64:67], v[108:111], v[48:51]
    v_mfma_f32_16x16x32_bf16 v[44:47], v[64:67], v[104:107], v[44:47]
    s_add_u32 s95, s82, s99
    buffer_load_dwordx4 a[72:75], v4, s[40:43], s95 offen offset:1024 sc1
    v_mfma_f32_16x16x32_bf16 v[40:43], v[64:67], v[100:103], v[40:43]
    v_mfma_f32_16x16x32_bf16 v[36:39], v[64:67], v[96:99], v[36:39]
    v_mfma_f32_16x16x32_bf16 v[32:35], v[64:67], v[92:95], v[32:35]
    s_add_u32 s95, s83, s99
    buffer_load_dwordx4 a[76:79], v4, s[40:43], s95 offen offset:1024 sc1
    v_mfma_f32_16x16x32_bf16 v[56:59], v[68:71], v[112:115], v[56:59]
    ds_read_b64 v[64:65], v124 offset:512
    ds_read_b64 v[66:67], v124 offset:520
    ds_read_b128 v[116:119], v125 offset:512
    v_mfma_f32_16x16x32_bf16 v[52:55], v[68:71], v[108:111], v[52:55]
    v_mfma_f32_16x16x32_bf16 v[48:51], v[68:71], v[104:107], v[48:51]
    s_add_u32 s95, s82, s100
    buffer_load_dwordx4 a[80:83], v4, s[40:43], s95 offen offset:0 sc1
    v_mfma_f32_16x16x32_bf16 v[44:47], v[68:71], v[100:103], v[44:47]
    v_mfma_f32_16x16x32_bf16 v[40:43], v[68:71], v[96:99], v[40:43]
    v_mfma_f32_16x16x32_bf16 v[36:39], v[68:71], v[92:95], v[36:39]
    s_add_u32 s95, s83, s100
    buffer_load_dwordx4 a[84:87], v4, s[40:43], s95 offen offset:0 sc1
    v_mfma_f32_16x16x32_bf16 v[56:59], v[72:75], v[108:111], v[56:59]
    ds_read_b64 v[68:69], v124 offset:1024
    ds_read_b64 v[70:71], v124 offset:1032
    ds_read_b128 v[112:115], v125 offset:1024
    v_mfma_f32_16x16x32_bf16 v[52:55], v[72:75], v[104:107], v[52:55]
    v_mfma_f32_16x16x32_bf16 v[48:51], v[72:75], v[100:103], v[48:51]
    s_add_u32 s95, s82, s100
    buffer_load_dwordx4 a[88:91], v4, s[40:43], s95 offen offset:1024 sc1
    v_mfma_f32_16x16x32_bf16 v[44:47], v[72:75], v[96:99], v[44:47]
    v_mfma_f32_16x16x32_bf16 v[40:43], v[72:75], v[92:95], v[40:43]
    v_mfma_f32_16x16x32_bf16 v[56:59], v[76:79], v[104:107], v[56:59]
    ds_read_b64 v[72:73], v124 offset:1536
    ds_read_b64 v[74:75], v124 offset:1544
    ds_read_b128 v[108:111], v125 offset:1536
    s_add_u32 s95, s83, s100
    buffer_load_dwordx4 a[92:95], v4, s[40:43], s95 offen offset:1024 sc1
    v_mfma_f32_16x16x32_bf16 v[52:55], v[76:79], v[100:103], v[52:55]
    v_mfma_f32_16x16x32_bf16 v[48:51], v[76:79], v[96:99], v[48:51]
    v_mfma_f32_16x16x32_bf16 v[44:47], v[76:79], v[92:95], v[44:47]
    s_add_u32 s95, s82, s101
    buffer_load_dwordx4 a[96:99], v4, s[40:43], s95 offen offset:0 sc1
    v_mfma_f32_16x16x32_bf16 v[56:59], v[80:83], v[100:103], v[56:59]
    ds_read_b64 v[76:77], v124 offset:2048
    ds_read_b64 v[78:79], v124 offset:2056
    ds_read_b128 v[104:107], v125 offset:2048
    v_mfma_f32_16x16x32_bf16 v[52:55], v[80:83], v[96:99], v[52:55]
    v_mfma_f32_16x16x32_bf16 v[48:51], v[80:83], v[92:95], v[48:51]
    s_add_u32 s95, s83, s101
    buffer_load_dwordx4 a[100:103], v4, s[40:43], s95 offen offset:0 sc1
    v_mfma_f32_16x16x32_bf16 v[56:59], v[84:87], v[96:99], v[56:59]
    ds_read_b64 v[80:81], v124 offset:2560
    ds_read_b64 v[82:83], v124 offset:2568
    ds_read_b128 v[100:103], v125 offset:2560
    v_mfma_f32_16x16x32_bf16 v[52:55], v[84:87], v[92:95], v[52:55]
    v_mfma_f32_16x16x32_bf16 v[56:59], v[88:91], v[92:95], v[56:59]
    ds_read_b64 v[84:85], v124 offset:3072
    ds_read_b64 v[86:87], v124 offset:3080
    ds_read_b128 v[96:99], v125 offset:3072
    s_add_u32 s95, s82, s101
    buffer_load_dwordx4 a[104:107], v4, s[40:43], s95 offen offset:1024 sc1
    s_add_u32 s95, s83, s101
    buffer_load_dwordx4 a[108:111], v4, s[40:43], s95 offen offset:1024 sc1
    ds_read_b64 v[88:89], v124 offset:3584
    ds_read_b64 v[90:91], v124 offset:3592
    ds_read_b128 v[92:95], v125 offset:3584
    s_cmp_lg_u32 s3, 1
    s_cbranch_scc1 L_wskip_42
    s_lshl_b32 s88, s4, 7
    s_add_u32 s88, s88, 0x4000
    v_lshlrev_b32 v20, 3, v1
    v_add_u32 v20, s88, v20
    s_mov_b32 s90, 0xff
    s_mov_b32 s91, 0
    s_mov_b64 exec, s[90:91]
    s_mov_b32 s89, 0
L_wloop_43:
    buffer_load_dwordx2 v[22:23], v20, s[40:43], 0 offen sc1
    s_waitcnt vmcnt(0)
    v_cmp_eq_u32 vcc, s52, v22
    v_cmp_eq_u32 s[92:93], s53, v23
    s_nop 1
    s_and_b64 vcc, vcc, s[92:93]
    s_cmp_eq_u64 vcc, exec
    s_cbranch_scc1 L_wdone_44
    s_add_u32 s89, s89, 1
    s_cmp_lt_u32 s89, 0x8000
    s_cbranch_scc1 L_wloop_43
    s_or_b32 s80, s80, 8
L_wdone_44:
    s_mov_b64 exec, -1
L_wskip_42:
    s_barrier
    s_mul_i32 s73, s4, 229376
    s_lshr_b32 s93, s3, 1
    s_mul_i32 s93, s93, 57344
    s_add_u32 s73, s73, s93
    s_and_b32 s93, s3, 1
    s_lshl_b32 s93, s93, 12
    s_add_u32 s73, s73, s93
    s_add_u32 s73, s73, 0xa00000
    s_lshl_b32 s74, s3, 12
    s_lshl_b32 s94, s68, 2
    s_add_u32 s94, s94, s73
    s_add_u32 m0, s74, 0
    s_nop 0
    buffer_load_dwordx4 v4, s[40:43], s94 offen sc1 lds
    buffer_load_dwordx4 v4, s[40:43], s94 offen offset:1024 sc1 lds
    buffer_load_dwordx4 v4, s[40:43], s94 offen offset:2048 sc1 lds
    buffer_load_dwordx4 v4, s[40:43], s94 offen offset:3072 sc1 lds
    s_waitcnt lgkmcnt(15)
    v_mfma_f32_16x16x32_bf16 v[56:59], v[60:63], v[120:123], v[56:59]
    s_waitcnt lgkmcnt(15)
    v_mfma_f32_16x16x32_bf16 v[52:55], v[60:63], v[116:119], v[52:55]
    s_waitcnt lgkmcnt(15)
    v_mfma_f32_16x16x32_bf16 v[48:51], v[60:63], v[112:115], v[48:51]
    s_waitcnt lgkmcnt(12)
    v_mfma_f32_16x16x32_bf16 v[44:47], v[60:63], v[108:111], v[44:47]
    s_waitcnt lgkmcnt(9)
    v_mfma_f32_16x16x32_bf16 v[40:43], v[60:63], v[104:107], v[40:43]
    s_waitcnt lgkmcnt(6)
    v_mfma_f32_16x16x32_bf16 v[36:39], v[60:63], v[100:103], v[36:39]
    s_waitcnt lgkmcnt(3)
    v_mfma_f32_16x16x32_bf16 v[32:35], v[60:63], v[96:99], v[32:35]
    s_waitcnt lgkmcnt(0)
    v_mfma_f32_16x16x32_bf16 v[28:31], v[60:63], v[92:95], v[28:31]
    v_mfma_f32_16x16x32_bf16 v[56:59], v[64:67], v[116:119], v[56:59]
    v_mfma_f32_16x16x32_bf16 v[52:55], v[64:67], v[112:115], v[52:55]
    v_mfma_f32_16x16x32_bf16 v[48:51], v[64:67], v[108:111], v[48:51]
    v_mfma_f32_16x16x32_bf16 v[44:47], v[64:67], v[104:107], v[44:47]
    v_mfma_f32_16x16x32_bf16 v[40:43], v[64:67], v[100:103], v[40:43]
    v_mfma_f32_16x16x32_bf16 v[36:39], v[64:67], v[96:99], v[36:39]
    v_mfma_f32_16x16x32_bf16 v[32:35], v[64:67], v[92:95], v[32:35]
    v_mfma_f32_16x16x32_bf16 v[56:59], v[68:71], v[112:115], v[56:59]
    v_mfma_f32_16x16x32_bf16 v[52:55], v[68:71], v[108:111], v[52:55]
    v_mfma_f32_16x16x32_bf16 v[48:51], v[68:71], v[104:107], v[48:51]
    s_lshl_b32 s94, s69, 2
    s_add_u32 s94, s94, s73
    s_add_u32 m0, s74, 32768
    s_nop 0
    buffer_load_dwordx4 v4, s[40:43], s94 offen sc1 lds
    buffer_load_dwordx4 v4, s[40:43], s94 offen offset:1024 sc1 lds
    buffer_load_dwordx4 v4, s[40:43], s94 offen offset:2048 sc1 lds
    buffer_load_dwordx4 v4, s[40:43], s94 offen offset:3072 sc1 lds
    v_mfma_f32_16x16x32_bf16 v[44:47], v[68:71], v[100:103], v[44:47]
    v_mfma_f32_16x16x32_bf16 v[40:43], v[68:71], v[96:99], v[40:43]
    v_mfma_f32_16x16x32_bf16 v[36:39], v[68:71], v[92:95], v[36:39]
    v_mfma_f32_16x16x32_bf16 v[56:59], v[72:75], v[108:111], v[56:59]
    v_mfma_f32_16x16x32_bf16 v[52:55], v[72:75], v[104:107], v[52:55]
    v_mfma_f32_16x16x32_bf16 v[48:51], v[72:75], v[100:103], v[48:51]
    v_mfma_f32_16x16x32_bf16 v[44:47], v[72:75], v[96:99], v[44:47]
    v_mfma_f32_16x16x32_bf16 v[40:43], v[72:75], v[92:95], v[40:43]
    v_mfma_f32_16x16x32_bf16 v[56:59], v[76:79], v[104:107], v[56:59]
    v_mfma_f32_16x16x32_bf16 v[52:55], v[76:79], v[100:103], v[52:55]
    v_mfma_f32_16x16x32_bf16 v[48:51], v[76:79], v[96:99], v[48:51]
    v_mfma_f32_16x16x32_bf16 v[44:47], v[76:79], v[92:95], v[44:47]
    v_mfma_f32_16x16x32_bf16 v[56:59], v[80:83], v[100:103], v[56:59]
    v_mfma_f32_16x16x32_bf16 v[52:55], v[80:83], v[96:99], v[52:55]
    v_mfma_f32_16x16x32_bf16 v[48:51], v[80:83], v[92:95], v[48:51]
    v_mfma_f32_16x16x32_bf16 v[56:59], v[84:87], v[96:99], v[56:59]
    v_mfma_f32_16x16x32_bf16 v[52:55], v[84:87], v[92:95], v[52:55]
    v_mfma_f32_16x16x32_bf16 v[56:59], v[88:91], v[92:95], v[56:59]
    s_mul_i32 s88, s6, 24576
    s_add_u32 s88, s88, 65536
    v_add_u32 v124, s88, v4
    s_mul_i32 s89, s7, 6144
    s_add_u32 s89, s89, s88
    v_add_u32 v125, s89, v4
    s_cmp_eq_u32 s7, 1
    s_cbranch_scc1 L_cvb_47
    s_cmp_eq_u32 s7, 2
    s_cbranch_scc1 L_cvb_48
    s_cmp_eq_u32 s7, 3
    s_cbranch_scc1 L_cvb_49
L_cvb_46:
    s_nop 3
    ds_write_b128 v124, v[36:39] offset:10240
    ds_write_b128 v124, v[40:43] offset:11264
    ds_write_b128 v124, v[44:47] offset:14336
    ds_write_b128 v124, v[48:51] offset:15360
    ds_write_b128 v124, v[52:55] offset:18432
    ds_write_b128 v124, v[56:59] offset:19456
    v_mov_b32 v60, v28
    v_mov_b32 v61, v29
    v_mov_b32 v62, v30
    v_mov_b32 v63, v31
    v_mov_b32 v64, v32
    v_mov_b32 v65, v33
    v_mov_b32 v66, v34
    v_mov_b32 v67, v35
    s_nop 0
    s_branch L_cvj_45
L_cvb_47:
    s_nop 3
    ds_write_b128 v124, v[28:31] offset:0
    ds_write_b128 v124, v[32:35] offset:1024
    ds_write_b128 v124, v[44:47] offset:16384
    ds_write_b128 v124, v[48:51] offset:17408
    ds_write_b128 v124, v[52:55] offset:20480
    ds_write_b128 v124, v[56:59] offset:21504
    v_mov_b32 v60, v36
    v_mov_b32 v61, v37
    v_mov_b32 v62, v38
    v_mov_b32 v63, v39
    v_mov_b32 v64, v40
    v_mov_b32 v65, v41
    v_mov_b32 v66, v42
    v_mov_b32 v67, v43
    s_nop 0
    s_branch L_cvj_45
L_cvb_48:
    s_nop 3
    ds_write_b128 v124, v[28:31] offset:2048
    ds_write_b128 v124, v[32:35] offset:3072
    ds_write_b128 v124, v[36:39] offset:6144
    ds_write_b128 v124, v[40:43] offset:7168
    ds_write_b128 v124, v[52:55] offset:22528
    ds_write_b128 v124, v[56:59] offset:23552
    v_mov_b32 v60, v44
    v_mov_b32 v61, v45
    v_mov_b32 v62, v46
    v_mov_b32 v63, v47
    v_mov_b32 v64, v48
    v_mov_b32 v65, v49
    v_mov_b32 v66, v50
    v_mov_b32 v67, v51
    s_nop 0
    s_branch L_cvj_45
L_cvb_49:
    s_nop 3
    ds_write_b128 v124, v[28:31] offset:4096
    ds_write_b128 v124, v[32:35] offset:5120
    ds_write_b128 v124, v[36:39] offset:8192
    ds_write_b128 v124, v[40:43] offset:9216
    ds_write_b128 v124, v[44:47] offset:12288
    ds_write_b128 v124, v[48:51] offset:13312
    v_mov_b32 v60, v52
    v_mov_b32 v61, v53
    v_mov_b32 v62, v54
    v_mov_b32 v63, v55
    v_mov_b32 v64, v56
    v_mov_b32 v65, v57
    v_mov_b32 v66, v58
    v_mov_b32 v67, v59
L_cvj_45:
    v_lshlrev_b32 v126, 5, v2
    v_lshl_add_u32 v126, v3, 3, v126
    s_lshl_b32 s90, s7, 10
    s_sub_u32 s92, s85, s90
    s_add_u32 s92, s92, 3576
    v_sub_u32 v127, s92, v126
    ds_read_b64 v[92:93], v127 offset:512
    ds_read_b64 v[94:95], v127 offset:0
    v_lshrrev_b32 v126, 5, v1
    v_lshlrev_b32 v126, 9, v126
    v_lshl_add_u32 v126, v2, 5, v126
    v_and_b32 v127, 1, v3
    v_lshl_add_u32 v126, v127, 4, v126
    s_add_u32 s88, s86, s90
    s_add_u32 s88, s88, 0x800000
    s_waitcnt lgkmcnt(0)
    v_and_b32 v100, 0xffff0000, v93
    v_lshlrev_b32 v101, 16, v93
    v_and_b32 v102, 0xffff0000, v92
    v_lshlrev_b32 v103, 16, v92
    v_and_b32 v104, 0xffff0000, v95
    v_lshlrev_b32 v105, 16, v95
    v_and_b32 v106, 0xffff0000, v94
    v_lshlrev_b32 v107, 16, v94
    v_fma_f32 v60, v100, s84, v60
    v_fma_f32 v61, v101, s84, v61
    v_fma_f32 v62, v102, s84, v62
    v_fma_f32 v63, v103, s84, v63
    v_fma_f32 v64, v104, s84, v64
    v_fma_f32 v65, v105, s84, v65
    v_fma_f32 v66, v106, s84, v66
    v_fma_f32 v67, v107, s84, v67
    s_barrier
    ds_read_b128 v[68:71], v125 offset:0
    ds_read_b128 v[72:75], v125 offset:1024
    ds_read_b128 v[76:79], v125 offset:2048
    ds_read_b128 v[80:83], v125 offset:3072
    ds_read_b128 v[84:87], v125 offset:4096
    ds_read_b128 v[88:91], v125 offset:5120
    s_waitcnt lgkmcnt(4)
    v_pk_add_f32 v[60:61], v[60:61], v[68:69]
    v_pk_add_f32 v[62:63], v[62:63], v[70:71]
    v_pk_add_f32 v[64:65], v[64:65], v[72:73]
    v_pk_add_f32 v[66:67], v[66:67], v[74:75]
    s_waitcnt lgkmcnt(2)
    v_pk_add_f32 v[60:61], v[60:61], v[76:77]
    v_pk_add_f32 v[62:63], v[62:63], v[78:79]
    v_pk_add_f32 v[64:65], v[64:65], v[80:81]
    v_pk_add_f32 v[66:67], v[66:67], v[82:83]
    s_waitcnt lgkmcnt(0)
    v_pk_add_f32 v[60:61], v[60:61], v[84:85]
    v_pk_add_f32 v[62:63], v[62:63], v[86:87]
    v_pk_add_f32 v[64:65], v[64:65], v[88:89]
    v_pk_add_f32 v[66:67], v[66:67], v[90:91]
    v_cvt_pk_bf16_f32 v100, v60, v61
    v_cvt_pk_bf16_f32 v101, v62, v63
    v_cvt_pk_bf16_f32 v102, v64, v65
    v_cvt_pk_bf16_f32 v103, v66, v67
    s_nop 0
    v_permlane32_swap_b32 v100, v102
    v_permlane32_swap_b32 v101, v103
    s_nop 0
    v_permlane16_swap_b32 v100, v102
    v_permlane16_swap_b32 v101, v103
    buffer_store_dwordx4 v[100:103], v126, s[40:43], s88 offen sc0 sc1
    s_and_b32 s88, s7, 1
    s_lshl_b32 s89, s6, 1
    s_add_u32 s88, s88, s89
    s_lshl_b32 s88, s88, 13
    s_lshl_b32 s89, s6, 11
    s_add_u32 s90, s88, s89
    s_sub_u32 s89, 0x800, s89
    s_add_u32 s91, s88, s89
    v_add_u32 v92, s90, v4
    v_add_u32 v93, s91, v4
    v_add_u32 v94, s90, v4
    v_add_u32 v95, s91, v4
    v_add_u32 v94, 0x10000, v94
    v_add_u32 v95, 0x10000, v95
    v_add_u32 v96, s90, v4
    v_add_u32 v97, s91, v4
    v_add_u32 v96, 0x20000, v96
    v_add_u32 v97, 0x20000, v97
    s_waitcnt vmcnt(5)
    s_barrier
    ds_read_b128 v[60:63], v92 offset:0
    ds_read_b128 v[64:67], v92 offset:1024
    ds_read_b128 v[68:71], v93 offset:0
    ds_read_b128 v[72:75], v93 offset:1024
    s_waitcnt lgkmcnt(3)
    v_mfma_f32_16x16x32_bf16 v[28:31], a[0:3], v[60:63], 0
    ds_read_b128 v[76:79], v92 offset:4096
    v_mfma_f32_16x16x32_bf16 v[32:35], a[4:7], v[60:63], 0
    s_lshl_b32 s94, s70, 2
    s_add_u32 s94, s94, s73
    s_add_u32 m0, s74, 65536
    s_nop 0
    buffer_load_dwordx4 v4, s[40:43], s94 offen sc1 lds
    buffer_load_dwordx4 v4, s[40:43], s94 offen offset:1024 sc1 lds
    buffer_load_dwordx4 v4, s[40:43], s94 offen offset:2048 sc1 lds
    buffer_load_dwordx4 v4, s[40:43], s94 offen offset:3072 sc1 lds
    s_waitcnt lgkmcnt(3)
    v_mfma_f32_16x16x32_bf16 v[36:39], a[0:3], v[64:67], 0
    ds_read_b128 v[80:83], v92 offset:5120
    v_mfma_f32_16x16x32_bf16 v[40:43], a[4:7], v[64:67], 0
    s_waitcnt lgkmcnt(3)
    v_mfma_f32_16x16x32_bf16 v[44:47], a[0:3], v[68:71], 0
    ds_read_b128 v[84:87], v93 offset:4096
    v_mfma_f32_16x16x32_bf16 v[48:51], a[4:7], v[68:71], 0
    s_waitcnt lgkmcnt(3)
    v_mfma_f32_16x16x32_bf16 v[52:55], a[0:3], v[72:75], 0
    ds_read_b128 v[88:91], v93 offset:5120
    v_mfma_f32_16x16x32_bf16 v[56:59], a[4:7], v[72:75], 0
    s_waitcnt vmcnt(5)
    s_waitcnt vmcnt(4)
    s_barrier
    s_cmp_lg_u32 s3, 0
    s_cbranch_scc1 L_sig_50
    s_lshl_b32 s88, s5, 8
    s_lshl_b32 s89, s4, 3
    s_add_u32 s88, s88, s89
    s_add_u32 s88, s88, 0x5000
    v_mov_b32 v20, s52
    v_mov_b32 v21, s53
    v_mov_b32 v22, s88
    s_mov_b64 exec, 1
    buffer_store_dwordx2 v[20:21], v22, s[40:43], 0 offen sc0 sc1
    s_mov_b64 exec, -1
L_sig_50:
    s_waitcnt lgkmcnt(3)
    v_mfma_f32_16x16x32_bf16 v[28:31], a[8:11], v[76:79], v[28:31]
    ds_read_b128 v[60:63], v92 offset:32768
    v_mfma_f32_16x16x32_bf16 v[32:35], a[12:15], v[76:79], v[32:35]
    v_lshlrev_b32 v100, 16, v8
    v_and_b32 v101, 0xffff0000, v8
    s_waitcnt lgkmcnt(3)
    v_mfma_f32_16x16x32_bf16 v[36:39], a[8:11], v[80:83], v[36:39]
    ds_read_b128 v[64:67], v92 offset:33792
    v_mfma_f32_16x16x32_bf16 v[40:43], a[12:15], v[80:83], v[40:43]
    v_lshlrev_b32 v108, 16, v16
    v_and_b32 v109, 0xffff0000, v16
    s_waitcnt lgkmcnt(3)
    v_mfma_f32_16x16x32_bf16 v[44:47], a[8:11], v[84:87], v[44:47]
    ds_read_b128 v[68:71], v93 offset:32768
    v_mfma_f32_16x16x32_bf16 v[48:51], a[12:15], v[84:87], v[48:51]
    v_add_f32 v100, v100, v108
    v_add_f32 v101, v101, v109
    s_waitcnt lgkmcnt(3)
    v_mfma_f32_16x16x32_bf16 v[52:55], a[8:11], v[88:91], v[52:55]
    ds_read_b128 v[72:75], v93 offset:33792
    v_mfma_f32_16x16x32_bf16 v[56:59], a[12:15], v[88:91], v[56:59]
    v_lshlrev_b32 v108, 16, v12
    v_and_b32 v109, 0xffff0000, v12
    v_lshlrev_b32 v102, 16, v9
    v_and_b32 v103, 0xffff0000, v9
    v_lshlrev_b32 v110, 16, v17
    v_and_b32 v111, 0xffff0000, v17
    s_waitcnt lgkmcnt(3)
    v_mfma_f32_16x16x32_bf16 v[28:31], a[16:19], v[60:63], v[28:31]
    ds_read_b128 v[76:79], v92 offset:36864
    v_mfma_f32_16x16x32_bf16 v[32:35], a[20:23], v[60:63], v[32:35]
    s_lshl_b32 s94, s71, 2
    s_add_u32 s94, s94, s73
    s_add_u32 m0, s74, 98304
    s_nop 0
    buffer_load_dwordx4 v4, s[40:43], s94 offen sc1 lds
    buffer_load_dwordx4 v4, s[40:43], s94 offen offset:1024 sc1 lds
    buffer_load_dwordx4 v4, s[40:43], s94 offen offset:2048 sc1 lds
    buffer_load_dwordx4 v4, s[40:43], s94 offen offset:3072 sc1 lds
    v_add_f32 v102, v102, v110
    s_waitcnt lgkmcnt(3)
    v_mfma_f32_16x16x32_bf16 v[36:39], a[16:19], v[64:67], v[36:39]
    ds_read_b128 v[80:83], v92 offset:37888
    v_mfma_f32_16x16x32_bf16 v[40:43], a[20:23], v[64:67], v[40:43]
    v_add_f32 v103, v103, v111
    v_lshlrev_b32 v110, 16, v13
    s_waitcnt lgkmcnt(3)
    v_mfma_f32_16x16x32_bf16 v[44:47], a[16:19], v[68:71], v[44:47]
    ds_read_b128 v[84:87], v93 offset:36864
    v_mfma_f32_16x16x32_bf16 v[48:51], a[20:23], v[68:71], v[48:51]
    v_and_b32 v111, 0xffff0000, v13
    v_lshlrev_b32 v104, 16, v10
    s_waitcnt lgkmcnt(3)
    v_mfma_f32_16x16x32_bf16 v[52:55], a[16:19], v[72:75], v[52:55]
    ds_read_b128 v[88:91], v93 offset:37888
    v_mfma_f32_16x16x32_bf16 v[56:59], a[20:23], v[72:75], v[56:59]
    v_and_b32 v105, 0xffff0000, v10
    v_lshlrev_b32 v112, 16, v18
    v_and_b32 v113, 0xffff0000, v18
    v_add_f32 v104, v104, v112
    v_add_f32 v105, v105, v113
    v_lshlrev_b32 v112, 16, v14
    v_and_b32 v113, 0xffff0000, v14
    s_waitcnt vmcnt(4)
    s_barrier
    s_waitcnt lgkmcnt(3)
    v_mfma_f32_16x16x32_bf16 v[28:31], a[24:27], v[76:79], v[28:31]
    ds_read_b128 v[60:63], v94 offset:0
    v_mfma_f32_16x16x32_bf16 v[32:35], a[28:31], v[76:79], v[32:35]
    v_lshlrev_b32 v106, 16, v11
    v_and_b32 v107, 0xffff0000, v11
    s_waitcnt lgkmcnt(3)
    v_mfma_f32_16x16x32_bf16 v[36:39], a[24:27], v[80:83], v[36:39]
    ds_read_b128 v[64:67], v94 offset:1024
    v_mfma_f32_16x16x32_bf16 v[40:43], a[28:31], v[80:83], v[40:43]
    v_lshlrev_b32 v114, 16, v19
    v_and_b32 v115, 0xffff0000, v19
    s_waitcnt lgkmcnt(3)
    v_mfma_f32_16x16x32_bf16 v[44:47], a[24:27], v[84:87], v[44:47]
    ds_read_b128 v[68:71], v95 offset:0
    v_mfma_f32_16x16x32_bf16 v[48:51], a[28:31], v[84:87], v[48:51]
    v_add_f32 v106, v106, v114
    v_add_f32 v107, v107, v115
    s_waitcnt lgkmcnt(3)
    v_mfma_f32_16x16x32_bf16 v[52:55], a[24:27], v[88:91], v[52:55]
    ds_read_b128 v[72:75], v95 offset:1024
    v_mfma_f32_16x16x32_bf16 v[56:59], a[28:31], v[88:91], v[56:59]
    v_lshlrev_b32 v114, 16, v15
    v_and_b32 v115, 0xffff0000, v15
    v_lshrrev_b32 v116, 3, v1
    v_lshlrev_b32 v116, 12, v116
    v_and_b32 v117, 7, v1
    v_lshl_add_u32 v116, v117, 4, v116
    s_waitcnt lgkmcnt(3)
    v_mfma_f32_16x16x32_bf16 v[28:31], a[32:35], v[60:63], v[28:31]
    ds_read_b128 v[76:79], v94 offset:4096
    v_mfma_f32_16x16x32_bf16 v[32:35], a[36:39], v[60:63], v[32:35]
    s_lshl_b32 s94, s99, 2
    s_add_u32 s94, s94, s73
    s_add_u32 m0, s74, 131072
    s_nop 0
    buffer_load_dwordx4 v4, s[40:43], s94 offen sc1 lds
    buffer_load_dwordx4 v4, s[40:43], s94 offen offset:1024 sc1 lds
    buffer_load_dwordx4 v4, s[40:43], s94 offen offset:2048 sc1 lds
    buffer_load_dwordx4 v4, s[40:43], s94 offen offset:3072 sc1 lds
    s_waitcnt lgkmcnt(3)
    v_mfma_f32_16x16x32_bf16 v[36:39], a[32:35], v[64:67], v[36:39]
    ds_read_b128 v[80:83], v94 offset:5120
    v_mfma_f32_16x16x32_bf16 v[40:43], a[36:39], v[64:67], v[40:43]
    s_waitcnt lgkmcnt(3)
    v_mfma_f32_16x16x32_bf16 v[44:47], a[32:35], v[68:71], v[44:47]
    ds_read_b128 v[84:87], v95 offset:4096
    v_mfma_f32_16x16x32_bf16 v[48:51], a[36:39], v[68:71], v[48:51]
    s_waitcnt lgkmcnt(3)
    v_mfma_f32_16x16x32_bf16 v[52:55], a[32:35], v[72:75], v[52:55]
    ds_read_b128 v[88:91], v95 offset:5120
    v_mfma_f32_16x16x32_bf16 v[56:59], a[36:39], v[72:75], v[56:59]
    s_waitcnt vmcnt(4)
    s_barrier
    s_waitcnt lgkmcnt(3)
    v_mfma_f32_16x16x32_bf16 v[28:31], a[40:43], v[76:79], v[28:31]
    ds_read_b128 v[60:63], v94 offset:32768
    v_mfma_f32_16x16x32_bf16 v[32:35], a[44:47], v[76:79], v[32:35]
    s_lshl_b32 s75, s5, 18
    s_lshl_b32 s89, s4, 7
    s_waitcnt lgkmcnt(3)
    v_mfma_f32_16x16x32_bf16 v[36:39], a[40:43], v[80:83], v[36:39]
    ds_read_b128 v[64:67], v94 offset:33792
    v_mfma_f32_16x16x32_bf16 v[40:43], a[44:47], v[80:83], v[40:43]
    s_add_u32 s75, s75, s89
    s_lshl_b32 s89, s3, 15
    s_waitcnt lgkmcnt(3)
    v_mfma_f32_16x16x32_bf16 v[44:47], a[40:43], v[84:87], v[44:47]
    ds_read_b128 v[68:71], v95 offset:32768
    v_mfma_f32_16x16x32_bf16 v[48:51], a[44:47], v[84:87], v[48:51]
    s_add_u32 s75, s75, s89
    s_xor_b32 s89, s3, 1
    s_waitcnt lgkmcnt(3)
    v_mfma_f32_16x16x32_bf16 v[52:55], a[40:43], v[88:91], v[52:55]
    ds_read_b128 v[72:75], v95 offset:33792
    v_mfma_f32_16x16x32_bf16 v[56:59], a[44:47], v[88:91], v[56:59]
    s_mul_i32 s89, s89, 6144
    s_add_u32 s89, s89, 73728
    v_add_u32 v118, s89, v4
    s_xor_b32 s89, s3, 4
    s_mul_i32 s89, s89, 6144
    s_add_u32 s89, s89, 75776
    v_add_u32 v119, s89, v4
    s_xor_b32 s89, s3, 5
    s_mul_i32 s89, s89, 6144
    s_add_u32 s89, s89, 77824
    v_add_u32 v120, s89, v4
    s_waitcnt lgkmcnt(3)
    v_mfma_f32_16x16x32_bf16 v[28:31], a[48:51], v[60:63], v[28:31]
    ds_read_b128 v[76:79], v94 offset:36864
    v_mfma_f32_16x16x32_bf16 v[32:35], a[52:55], v[60:63], v[32:35]
    s_lshl_b32 s94, s100, 2
    s_add_u32 s94, s94, s73
    s_add_u32 m0, s74, 0
    s_nop 0
    buffer_load_dwordx4 v4, s[40:43], s94 offen sc1 lds
    buffer_load_dwordx4 v4, s[40:43], s94 offen offset:1024 sc1 lds
    buffer_load_dwordx4 v4, s[40:43], s94 offen offset:2048 sc1 lds
    buffer_load_dwordx4 v4, s[40:43], s94 offen offset:3072 sc1 lds
    s_waitcnt lgkmcnt(3)
    v_mfma_f32_16x16x32_bf16 v[36:39], a[48:51], v[64:67], v[36:39]
    ds_read_b128 v[80:83], v94 offset:37888
    v_mfma_f32_16x16x32_bf16 v[40:43], a[52:55], v[64:67], v[40:43]
    s_waitcnt lgkmcnt(3)
    v_mfma_f32_16x16x32_bf16 v[44:47], a[48:51], v[68:71], v[44:47]
    ds_read_b128 v[84:87], v95 offset:36864
    v_mfma_f32_16x16x32_bf16 v[48:51], a[52:55], v[68:71], v[48:51]
    s_waitcnt lgkmcnt(3)
    v_mfma_f32_16x16x32_bf16 v[52:55], a[48:51], v[72:75], v[52:55]
    ds_read_b128 v[88:91], v95 offset:37888
    v_mfma_f32_16x16x32_bf16 v[56:59], a[52:55], v[72:75], v[56:59]
    s_waitcnt vmcnt(4)
    s_barrier
    s_waitcnt lgkmcnt(3)
    v_mfma_f32_16x16x32_bf16 v[28:31], a[56:59], v[76:79], v[28:31]
    ds_read_b128 v[60:63], v96 offset:0
    v_mfma_f32_16x16x32_bf16 v[32:35], a[60:63], v[76:79], v[32:35]
    s_mul_i32 s89, s3, 6144
    s_add_u32 s89, s89, 73728
    s_waitcnt lgkmcnt(3)
    v_mfma_f32_16x16x32_bf16 v[36:39], a[56:59], v[80:83], v[36:39]
    ds_read_b128 v[64:67], v96 offset:1024
    v_mfma_f32_16x16x32_bf16 v[40:43], a[60:63], v[80:83], v[40:43]
    v_add_u32 v121, s89, v4
    v_lshrrev_b32 v122, 2, v2
    s_waitcnt lgkmcnt(3)
    v_mfma_f32_16x16x32_bf16 v[44:47], a[56:59], v[84:87], v[44:47]
    ds_read_b128 v[68:71], v97 offset:0
    v_mfma_f32_16x16x32_bf16 v[48:51], a[60:63], v[84:87], v[48:51]
    v_lshl_add_u32 v122, v3, 2, v122
    v_lshlrev_b32 v122, 7, v122
    s_waitcnt lgkmcnt(3)
    v_mfma_f32_16x16x32_bf16 v[52:55], a[56:59], v[88:91], v[52:55]
    ds_read_b128 v[72:75], v97 offset:1024
    v_mfma_f32_16x16x32_bf16 v[56:59], a[60:63], v[88:91], v[56:59]
    v_and_b32 v124, 3, v2
    v_lshl_add_u32 v122, v124, 3, v122
    s_lshl_b32 s88, s7, 11
    s_lshl_b32 s89, s6, 6
    s_add_u32 s88, s88, s89
    s_add_u32 s88, s88, 65536
    v_add_u32 v122, s88, v122
    s_waitcnt lgkmcnt(3)
    v_mfma_f32_16x16x32_bf16 v[28:31], a[64:67], v[60:63], v[28:31]
    ds_read_b128 v[76:79], v96 offset:4096
    v_mfma_f32_16x16x32_bf16 v[32:35], a[68:71], v[60:63], v[32:35]
    s_lshl_b32 s94, s101, 2
    s_add_u32 s94, s94, s73
    s_add_u32 m0, s74, 32768
    s_nop 0
    buffer_load_dwordx4 v4, s[40:43], s94 offen sc1 lds
    buffer_load_dwordx4 v4, s[40:43], s94 offen offset:1024 sc1 lds
    buffer_load_dwordx4 v4, s[40:43], s94 offen offset:2048 sc1 lds
    buffer_load_dwordx4 v4, s[40:43], s94 offen offset:3072 sc1 lds
    s_lshl_b32 s89, s6, 15
    s_waitcnt lgkmcnt(3)
    v_mfma_f32_16x16x32_bf16 v[36:39], a[64:67], v[64:67], v[36:39]
    ds_read_b128 v[80:83], v96 offset:5120
    v_mfma_f32_16x16x32_bf16 v[40:43], a[68:71], v[64:67], v[40:43]
    s_add_u32 s76, s79, s89
    s_lshl_b32 s89, s5, 7
    s_waitcnt lgkmcnt(3)
    v_mfma_f32_16x16x32_bf16 v[44:47], a[64:67], v[68:71], v[44:47]
    ds_read_b128 v[84:87], v97 offset:4096
    v_mfma_f32_16x16x32_bf16 v[48:51], a[68:71], v[68:71], v[48:51]
    s_add_u32 s76, s76, s89
    s_lshl_b32 s89, s7, 5
    s_waitcnt lgkmcnt(3)
    v_mfma_f32_16x16x32_bf16 v[52:55], a[64:67], v[72:75], v[52:55]
    ds_read_b128 v[88:91], v97 offset:5120
    v_mfma_f32_16x16x32_bf16 v[56:59], a[68:71], v[72:75], v[56:59]
    s_add_u32 s76, s76, s89
    v_lshrrev_b32 v123, 5, v1
    v_lshl_add_u32 v123, v123, 4, v2
    v_lshlrev_b32 v123, 10, v123
    v_and_b32 v124, 1, v3
    v_lshl_add_u32 v123, v124, 4, v123
    s_waitcnt vmcnt(4)
    s_barrier
    s_waitcnt lgkmcnt(3)
    v_mfma_f32_16x16x32_bf16 v[28:31], a[72:75], v[76:79], v[28:31]
    ds_read_b128 v[60:63], v92 offset:0
    v_mfma_f32_16x16x32_bf16 v[32:35], a[76:79], v[76:79], v[32:35]
    s_cmp_lg_u32 s3, 1
    s_cbranch_scc1 L_ep_51
    s_lshl_b32 s88, s5, 8
    s_add_u32 s88, s88, 0x5000
    v_lshlrev_b32 v20, 3, v1
    v_add_u32 v20, s88, v20
    s_mov_b32 exec_hi, 0
    buffer_load_dwordx2 v[22:23], v20, s[40:43], 0 offen sc1
    s_mov_b64 exec, -1
L_ep_51:
    s_waitcnt lgkmcnt(3)
    v_mfma_f32_16x16x32_bf16 v[36:39], a[72:75], v[80:83], v[36:39]
    ds_read_b128 v[64:67], v92 offset:1024
    v_mfma_f32_16x16x32_bf16 v[40:43], a[76:79], v[80:83], v[40:43]
    s_waitcnt lgkmcnt(3)
    v_mfma_f32_16x16x32_bf16 v[44:47], a[72:75], v[84:87], v[44:47]
    ds_read_b128 v[68:71], v93 offset:0
    v_mfma_f32_16x16x32_bf16 v[48:51], a[76:79], v[84:87], v[48:51]
    s_waitcnt lgkmcnt(3)
    v_mfma_f32_16x16x32_bf16 v[52:55], a[72:75], v[88:91], v[52:55]
    ds_read_b128 v[72:75], v93 offset:1024
    v_mfma_f32_16x16x32_bf16 v[56:59], a[76:79], v[88:91], v[56:59]
    s_waitcnt lgkmcnt(3)
    v_mfma_f32_16x16x32_bf16 v[28:31], a[80:83], v[60:63], v[28:31]
    ds_read_b128 v[76:79], v92 offset:4096
    v_mfma_f32_16x16x32_bf16 v[32:35], a[84:87], v[60:63], v[32:35]
    s_waitcnt lgkmcnt(3)
    v_mfma_f32_16x16x32_bf16 v[36:39], a[80:83], v[64:67], v[36:39]
    ds_read_b128 v[80:83], v92 offset:5120
    v_mfma_f32_16x16x32_bf16 v[40:43], a[84:87], v[64:67], v[40:43]
    s_waitcnt lgkmcnt(3)
    v_mfma_f32_16x16x32_bf16 v[44:47], a[80:83], v[68:71], v[44:47]
    ds_read_b128 v[84:87], v93 offset:4096
    v_mfma_f32_16x16x32_bf16 v[48:51], a[84:87], v[68:71], v[48:51]
    s_waitcnt lgkmcnt(3)
    v_mfma_f32_16x16x32_bf16 v[52:55], a[80:83], v[72:75], v[52:55]
    ds_read_b128 v[88:91], v93 offset:5120
    v_mfma_f32_16x16x32_bf16 v[56:59], a[84:87], v[72:75], v[56:59]
    s_waitcnt vmcnt(0)
    s_cmp_lg_u32 s3, 1
    s_cbranch_scc1 L_epok_52
    s_waitcnt vmcnt(0)
    s_mov_b32 exec_hi, 0
    v_cmp_eq_u32 vcc, s52, v22
    v_cmp_eq_u32 s[92:93], s53, v23
    s_nop 1
    s_and_b64 vcc, vcc, s[92:93]
    s_cmp_eq_u64 vcc, exec
    s_mov_b64 exec, -1
    s_cbranch_scc1 L_epok_52
    s_lshl_b32 s88, s5, 8
    s_add_u32 s88, s88, 0x5000
    v_lshlrev_b32 v20, 3, v1
    v_add_u32 v20, s88, v20
    s_mov_b32 s90, -1
    s_mov_b32 s91, 0
    s_mov_b64 exec, s[90:91]
    s_mov_b32 s89, 0
L_wloop_53:
    buffer_load_dwordx2 v[22:23], v20, s[40:43], 0 offen sc1
    s_waitcnt vmcnt(0)
    v_cmp_eq_u32 vcc, s52, v22
    v_cmp_eq_u32 s[92:93], s53, v23
    s_nop 1
    s_and_b64 vcc, vcc, s[92:93]
    s_cmp_eq_u64 vcc, exec
    s_cbranch_scc1 L_wdone_54
    s_add_u32 s89, s89, 1
    s_cmp_lt_u32 s89, 0x8000
    s_cbranch_scc1 L_wloop_53
    s_or_b32 s80, s80, 16
L_wdone_54:
    s_mov_b64 exec, -1
L_epok_52:
    s_barrier
    s_waitcnt lgkmcnt(3)
    v_mfma_f32_16x16x32_bf16 v[28:31], a[88:91], v[76:79], v[28:31]
    ds_read_b128 v[60:63], v92 offset:32768
    v_mfma_f32_16x16x32_bf16 v[32:35], a[92:95], v[76:79], v[32:35]
    s_add_u32 m0, s54, 65536
    s_add_u32 s95, s75, 8388608
    buffer_load_dwordx4 v116, s[40:43], s95 offen sc1 lds
    s_waitcnt lgkmcnt(3)
    v_mfma_f32_16x16x32_bf16 v[36:39], a[88:91], v[80:83], v[36:39]
    ds_read_b128 v[64:67], v92 offset:33792
    v_mfma_f32_16x16x32_bf16 v[40:43], a[92:95], v[80:83], v[40:43]
    s_waitcnt lgkmcnt(3)
    v_mfma_f32_16x16x32_bf16 v[44:47], a[88:91], v[84:87], v[44:47]
    ds_read_b128 v[68:71], v93 offset:32768
    v_mfma_f32_16x16x32_bf16 v[48:51], a[92:95], v[84:87], v[48:51]
    s_waitcnt lgkmcnt(3)
    v_mfma_f32_16x16x32_bf16 v[52:55], a[88:91], v[88:91], v[52:55]
    ds_read_b128 v[72:75], v93 offset:33792
    v_mfma_f32_16x16x32_bf16 v[56:59], a[92:95], v[88:91], v[56:59]
    s_waitcnt lgkmcnt(3)
    v_mfma_f32_16x16x32_bf16 v[28:31], a[96:99], v[60:63], v[28:31]
    ds_read_b128 v[76:79], v92 offset:36864
    v_mfma_f32_16x16x32_bf16 v[32:35], a[100:103], v[60:63], v[32:35]
    s_waitcnt lgkmcnt(3)
    v_mfma_f32_16x16x32_bf16 v[36:39], a[96:99], v[64:67], v[36:39]
    ds_read_b128 v[80:83], v92 offset:37888
    v_mfma_f32_16x16x32_bf16 v[40:43], a[100:103], v[64:67], v[40:43]
    s_waitcnt lgkmcnt(3)
    v_mfma_f32_16x16x32_bf16 v[44:47], a[96:99], v[68:71], v[44:47]
    ds_read_b128 v[84:87], v93 offset:36864
    v_mfma_f32_16x16x32_bf16 v[48:51], a[100:103], v[68:71], v[48:51]
    s_waitcnt lgkmcnt(3)
    v_mfma_f32_16x16x32_bf16 v[52:55], a[96:99], v[72:75], v[52:55]
    ds_read_b128 v[88:91], v93 offset:37888
    v_mfma_f32_16x16x32_bf16 v[56:59], a[100:103], v[72:75], v[56:59]
    s_waitcnt lgkmcnt(3)
    v_mfma_f32_16x16x32_bf16 v[28:31], a[104:107], v[76:79], v[28:31]
    v_mfma_f32_16x16x32_bf16 v[32:35], a[108:111], v[76:79], v[32:35]
    s_waitcnt lgkmcnt(2)
    v_mfma_f32_16x16x32_bf16 v[36:39], a[104:107], v[80:83], v[36:39]
    v_mfma_f32_16x16x32_bf16 v[40:43], a[108:111], v[80:83], v[40:43]
    s_waitcnt lgkmcnt(1)
    v_mfma_f32_16x16x32_bf16 v[44:47], a[104:107], v[84:87], v[44:47]
    v_mfma_f32_16x16x32_bf16 v[48:51], a[108:111], v[84:87], v[48:51]
    s_waitcnt lgkmcnt(0)
    v_mfma_f32_16x16x32_bf16 v[52:55], a[104:107], v[88:91], v[52:55]
    v_mfma_f32_16x16x32_bf16 v[56:59], a[108:111], v[88:91], v[56:59]
    ds_write_b128 v118, v[32:35] offset:0
    s_nop 0
    ds_write_b128 v118, v[40:43] offset:1024
    s_nop 0
    ds_write_b128 v119, v[44:47] offset:0
    s_nop 1
    ds_write_b128 v119, v[52:55] offset:1024
    ds_write_b128 v120, v[48:51] offset:0
    ds_write_b128 v120, v[56:59] offset:1024
    v_pk_add_f32 v[28:29], v[28:29], v[100:101]
    v_pk_add_f32 v[30:31], v[30:31], v[102:103]
    v_pk_add_f32 v[36:37], v[36:37], v[104:105]
    v_pk_add_f32 v[38:39], v[38:39], v[106:107]
    s_waitcnt lgkmcnt(0)
    s_waitcnt vmcnt(0)
    s_barrier
    ds_read_b128 v[60:63], v121 offset:0
    ds_read_b128 v[64:67], v121 offset:1024
    ds_read_b128 v[68:71], v121 offset:2048
    ds_read_b128 v[72:75], v121 offset:3072
    ds_read_b128 v[76:79], v121 offset:4096
    ds_read_b128 v[80:83], v121 offset:5120
    ds_read_b64_tr_b16 v[84:85], v122 offset:0
    ds_read_b64_tr_b16 v[86:87], v122 offset:32
    s_waitcnt lgkmcnt(6)
    v_pk_add_f32 v[28:29], v[28:29], v[60:61]
    v_pk_add_f32 v[30:31], v[30:31], v[62:63]
    v_pk_add_f32 v[36:37], v[36:37], v[64:65]
    v_pk_add_f32 v[38:39], v[38:39], v[66:67]
    s_waitcnt lgkmcnt(4)
    v_pk_add_f32 v[28:29], v[28:29], v[68:69]
    v_pk_add_f32 v[30:31], v[30:31], v[70:71]
    v_pk_add_f32 v[36:37], v[36:37], v[72:73]
    v_pk_add_f32 v[38:39], v[38:39], v[74:75]
    s_waitcnt lgkmcnt(2)
    v_pk_add_f32 v[28:29], v[28:29], v[76:77]
    v_pk_add_f32 v[30:31], v[30:31], v[78:79]
    v_pk_add_f32 v[36:37], v[36:37], v[80:81]
    v_pk_add_f32 v[38:39], v[38:39], v[82:83]
    s_waitcnt lgkmcnt(0)
    v_lshlrev_b32 v44, 16, v84
    v_and_b32 v45, 0xffff0000, v84
    v_lshlrev_b32 v46, 16, v85
    v_and_b32 v47, 0xffff0000, v85
    v_lshlrev_b32 v48, 16, v86
    v_and_b32 v49, 0xffff0000, v86
    v_lshlrev_b32 v50, 16, v87
    v_and_b32 v51, 0xffff0000, v87
    v_pk_fma_f32 v[28:29], v[108:109], v[44:45], v[28:29]
    v_pk_fma_f32 v[30:31], v[110:111], v[46:47], v[30:31]
    v_pk_fma_f32 v[36:37], v[112:113], v[48:49], v[36:37]
    v_pk_fma_f32 v[38:39], v[114:115], v[50:51], v[38:39]
    v_cvt_pk_bf16_f32 v88, v28, v29
    v_cvt_pk_bf16_f32 v89, v30, v31
    v_cvt_pk_bf16_f32 v90, v36, v37
    v_cvt_pk_bf16_f32 v91, v38, v39
    s_nop 0
    v_permlane32_swap_b32 v88, v90
    v_permlane32_swap_b32 v89, v91
    s_nop 0
    v_permlane16_swap_b32 v88, v90
    v_permlane16_swap_b32 v89, v91
    buffer_store_dwordx4 v[88:91], v123, s[36:39], s76 offen
    s_cmp_lg_u32 s2, 0
    s_cbranch_scc1 L_ep_55
    s_cmp_lg_u32 s3, 0
    s_cbranch_scc1 L_ep_55
    v_mov_b32 v108, s52
    v_mov_b32 v109, 0
    s_mov_b64 exec, 1
    buffer_store_dword v108, v109, s[40:43], 0 offen sc0 sc1
    s_mov_b64 exec, -1
L_ep_55:
L_end:
    s_endpgm
.section .rodata,"a"
.p2align 6
.amdhsa_kernel parallel_sum__ssm_conv_h3__mixer_s_mlp__prompt_kernel
  .amdhsa_next_free_vgpr 256
  .amdhsa_next_free_sgpr 102
  .amdhsa_accum_offset 128
  .amdhsa_group_segment_fixed_size 0
  .amdhsa_kernarg_size 112
  .amdhsa_user_sgpr_count 2
  .amdhsa_user_sgpr_kernarg_segment_ptr 1
  .amdhsa_system_sgpr_workgroup_id_x 1
.end_amdhsa_kernel
```
